```python
import torch

def _softmax(x, axis=-1):
    return torch.softmax(x, dim=axis)
def _gelu(x):
    return torch.nn.functional.gelu(x, approximate="tanh")
def _silu(x):
    return torch.nn.functional.silu(x)
def _sigmoid(x):
    return torch.sigmoid(x)
def _layernorm(x, axis=-1, eps=1e-5):
    m = x.mean(dim=axis, keepdim=True)
    v = x.var(dim=axis, keepdim=True, unbiased=False)
    return (x - m) / torch.sqrt(v + eps)
def _scatter_add(tgt, idx, src, axis=0):
    return tgt.clone().index_add_(axis, idx, src)
def _segment_sum(src, seg, n):
    out = torch.zeros((n,) + src.shape[1:], dtype=src.dtype)
    return out.index_add_(0, seg, src)
def _pad(x, pw):
    flat = tuple(v for pair in reversed(pw) for v in pair)
    return torch.nn.functional.pad(x, flat)

kernel_name = 'concat_heads__compressed_kv_cla__sliding_block_cached__decode'

def setup_inputs():

    _w = (lambda a: (lambda t: t.to(torch.bfloat16) if t.is_floating_point() else t)(torch.as_tensor(a)))
    def _A_setup():
        B, H, Sq, Sk, D, M = 1, 32, 1, 16384, 128, 576
        Dc = 4 * D
        return {
            "x": _w((lambda *s: torch.randn(*s, dtype=torch.bfloat16) * 3.2)(B, Sq, M)),
            "c_kv": _w((lambda *s: torch.randn(*s, dtype=torch.bfloat16) * 0.1)(B, Sk, Dc)),
            "w_q": _w((lambda *s: torch.randn(*s, dtype=torch.bfloat16) * 6.4)(M, H, D) * (M ** -0.5)),
            "w_uk": _w((lambda *s: torch.randn(*s, dtype=torch.bfloat16) * 6.4)(Dc, H, D) * (Dc ** -0.5)),
            "w_uv": _w((lambda *s: torch.randn(*s, dtype=torch.bfloat16) * 0.1)(Dc, H, D) * (Dc ** -0.5)),
            "w_o": _w((lambda *s: torch.randn(*s, dtype=torch.bfloat16) * 0.1)(H, D, M) * ((H * D) ** -0.5)),
        }
    _A_in = _A_setup()

    def _B_setup():
        B, Sq, D = 1, 1, 576
        Hq, Hkv, Sk, Dh = 32, 16, 16384, 128
        assert Hq % Hkv == 0, (Hq, Hkv)
        return {
            "x": _w((lambda *s: torch.randn(*s, dtype=torch.bfloat16) * 1.6)(B, Sq, D)),
            "k_cache": _w((lambda *s: torch.randn(*s, dtype=torch.bfloat16) * 1.6)(B, Hkv, Sk, Dh)),
            "v_cache": _w((lambda *s: torch.randn(*s, dtype=torch.bfloat16) * 0.05)(B, Hkv, Sk, Dh)),
            "wq": _w((lambda *s: torch.randn(*s, dtype=torch.bfloat16) * 1.6)(D, Hq * Dh) * (D ** -0.5)),
            "wo": _w((lambda *s: torch.randn(*s, dtype=torch.bfloat16) * 0.05)(Hq * Dh, D) * ((Hq * Dh) ** -0.5)),
        }
    _B_in = _B_setup()

    return {
        "A_x": _A_in["x"],
        "A_c_kv": _A_in["c_kv"],
        "A_w_q": _A_in["w_q"],
        "A_w_uk": _A_in["w_uk"],
        "A_w_uv": _A_in["w_uv"],
        "A_w_o": _A_in["w_o"],
        "B_x": _B_in["x"],
        "B_k_cache": _B_in["k_cache"],
        "B_v_cache": _B_in["v_cache"],
        "B_wq": _B_in["wq"],
        "B_wo": _B_in["wo"],
    }

def reference(A_x, A_c_kv, A_w_q, A_w_uk, A_w_uv, A_w_o, B_x, B_k_cache, B_v_cache, B_wq, B_wo):
    def _A_ref(x, c_kv, w_q, w_uk, w_uv, w_o):
        B, Sq, M = x.shape[0], x.shape[1], x.shape[2]
        Sk = c_kv.shape[1]
        H, D = w_q.shape[1], w_q.shape[2]
        q = torch.einsum("bqm,mhd->bhqd", x, w_q)
        k = torch.einsum("bkc,chd->bhkd", c_kv, w_uk)
        v = torch.einsum("bkc,chd->bhkd", c_kv, w_uv)
        scores = torch.einsum("bhqd,bhkd->bhqk", q, k) * (D ** -0.5)
        off = Sk - Sq
        qi = torch.arange(Sq)[:, None]
        kj = torch.arange(Sk)[None, :]
        cmask = kj <= (qi + off)
        scores = torch.where(cmask[None, None], scores, -1e9)
        p = _softmax(scores, axis=-1)
        ctx = torch.einsum("bhqk,bhkd->bhqd", p, v)
        return torch.einsum("bhqd,hdm->bqm", ctx, w_o)

    def _B_ref(x, k_cache, v_cache, wq, wo):
        B, Sq, D = x.shape
        Hq, Dh = 32, 128
        Hkv, Sk = k_cache.shape[1], k_cache.shape[2]
        W = min(4096, max(256, Sk // 4))
        rep = Hq // Hkv
        q = (lambda x, *d: x.permute(*d))((x @ wq).reshape(B, Sq, Hq, Dh), 0, 2, 1, 3)
        k = (lambda x, n, axis: torch.repeat_interleave(x, n, dim=axis))(k_cache[:, :, Sk - W:, :], rep, axis=1)
        v = (lambda x, n, axis: torch.repeat_interleave(x, n, dim=axis))(v_cache[:, :, Sk - W:, :], rep, axis=1)
        scores = torch.einsum("bhqd,bhkd->bhqk", q, k) * (Dh ** -0.5)
        p = _softmax(scores, axis=-1)
        o = torch.einsum("bhqk,bhkd->bhqd", p, v)
        return (lambda x, *d: x.permute(*d))(o, 0, 2, 1, 3).reshape(B, Sq, Hq * Dh) @ wo

    a = _A_ref(A_x, A_c_kv, A_w_q, A_w_uk, A_w_uv, A_w_o)
    b = _B_ref(B_x, B_k_cache, B_v_cache, B_wq, B_wo)
    return torch.concatenate([a, b], axis=-1)
```

```asm
; @launch grid=(256,1,1) block=(320,1,1) lds=163840
.amdgcn_target "amdgcn-amd-amdhsa--gfx950"
.text
.globl concat_heads__compressed_kv_cla__sliding_block_cached__decode_kernel
.p2align 8
.type concat_heads__compressed_kv_cla__sliding_block_cached__decode_kernel,@function
concat_heads__compressed_kv_cla__sliding_block_cached__decode_kernel:
L_start:
    s_cmp_ge_u32 s2, 256
    s_cbranch_scc1 L_exit
s_load_dwordx16 s[16:31], s[0:1], 0
    s_load_dwordx8 s[32:39], s[0:1], 64
    s_load_dwordx4 s[40:43], s[0:1], 96
    v_lshrrev_b32 v1, 6, v0
    v_and_b32 v0, 63, v0
    v_readfirstlane_b32 s3, v1
    v_lshrrev_b32 v1, 4, v0
    v_and_b32 v2, 15, v0
    v_lshlrev_b32 v3, 4, v0
    s_waitcnt lgkmcnt(0)
    s_load_dword s4, s[42:43], 0
s_mov_b32 s44, s42
    s_and_b32 s45, s43, 0xffff
    s_mov_b32 s46, 268435456
    s_mov_b32 s47, 0x20000
s_and_b32 s5, s2, 3
    s_lshl_b32 s5, s5, 5
    s_bfe_u32 s6, s2, 0x20005
    s_lshl_b32 s6, s6, 3
    s_add_u32 s5, s5, s6
    s_bfe_u32 s6, s2, 0x20003
    s_add_u32 s5, s5, s6
    s_and_b32 s6, s2, 4
    s_add_u32 s5, s5, s6
    s_xor_b32 s0, s5, 4
    s_xor_b32 s1, s0, 8
s_cmp_eq_u32 s3, 4
    s_cbranch_scc1 L_comm
    s_cmp_lt_u32 s2, 128
    s_cbranch_scc1 L_A
s_xor_b32 s5, s2, 128
s_mov_b32 s48, s34
    s_and_b32 s49, s35, 0xffff
    s_mov_b32 s50, 4718592
    s_mov_b32 s51, 0x20000
s_and_b32 s7, s5, 3
    s_mul_i32 s8, s7, 144
    s_mul_i32 s9, s3, 36
    s_add_u32 s8, s8, s9
    s_lshl_b32 s9, s8, 1
    s_add_u32 s10, s28, s9
    s_addc_u32 s11, s29, 0
    s_lshl_b32 s8, s8, 13
    s_lshr_b32 s9, s5, 2
    s_lshl_b32 s9, s9, 8
    s_add_u32 s8, s8, s9
    v_lshlrev_b32 v17, 4, v2
    v_lshl_add_u32 v17, v1, 13, v17
s_load_dwordx16 s[64:79], s[10:11], 0
    s_load_dwordx2 s[80:81], s[10:11], 64
buffer_load_dwordx4 v[128:131], v17, s[48:51], s8 offen nt
s_add_u32 s8, s8, 32768
buffer_load_dwordx4 v[132:135], v17, s[48:51], s8 offen nt
s_add_u32 s8, s8, 32768
buffer_load_dwordx4 v[136:139], v17, s[48:51], s8 offen nt
s_add_u32 s8, s8, 32768
s_waitcnt vmcnt(2)
buffer_load_dwordx4 v[140:143], v17, s[48:51], s8 offen nt
s_add_u32 s8, s8, 32768
s_waitcnt vmcnt(2)
buffer_load_dwordx4 v[144:147], v17, s[48:51], s8 offen nt
s_add_u32 s8, s8, 32768
s_waitcnt vmcnt(2)
buffer_load_dwordx4 v[148:151], v17, s[48:51], s8 offen nt
s_add_u32 s8, s8, 32768
s_waitcnt vmcnt(2)
buffer_load_dwordx4 v[152:155], v17, s[48:51], s8 offen nt
s_add_u32 s8, s8, 32768
s_waitcnt vmcnt(2)
buffer_load_dwordx4 v[156:159], v17, s[48:51], s8 offen nt
s_add_u32 s8, s8, 32768
s_waitcnt vmcnt(2)
buffer_load_dwordx4 v[160:163], v17, s[48:51], s8 offen nt
s_mov_b32 s48, s30
    s_and_b32 s49, s31, 0xffff
    s_mov_b32 s50, 67108864
    s_mov_b32 s51, 0x20000
s_mov_b32 s52, s32
    s_and_b32 s53, s33, 0xffff
    s_mov_b32 s54, 67108864
    s_mov_b32 s55, 0x20000
s_mov_b32 s56, s36
    s_and_b32 s57, s37, 0xffff
    s_mov_b32 s58, 4718592
    s_mov_b32 s59, 0x20000
s_sub_u32 s5, s2, 128
    s_lshr_b32 s6, s5, 3
    s_and_b32 s7, s5, 7
    s_lshl_b32 s8, s6, 22
    s_lshl_b32 s9, s7, 15
    s_add_u32 s8, s8, s9
    s_lshl_b32 s9, s3, 13
    s_add_u32 s8, s8, s9
    s_add_u32 s8, s8, 3145728
    s_mul_i32 s10, s2, 5
    s_mul_i32 s11, s3, 9
    s_add_u32 s10, s10, s11
    s_lshl_b32 s10, s10, 10

    s_lshl_b32 s11, s3, 15
    s_lshl_b32 s9, s6, 8
    s_lshl_b32 s14, s7, 5
    s_add_u32 s9, s9, s14
    s_mul_i32 s9, s9, 1152
    s_lshl_b32 s14, s3, 8
    s_add_u32 s9, s9, s14
    v_lshrrev_b32 v17, 3, v0
    v_mul_u32_u24 v16, 1152, v17
    v_and_b32 v17, 7, v0
    v_lshl_add_u32 v16, v17, 4, v16
    v_bfe_u32 v18, v0, 3, 1
    v_lshlrev_b32 v18, 1, v18
v_add_u32 v17, 1, v18
    v_lshl_or_b32 v17, v17, 8, v18
    v_and_b32 v19, 1, v0
    v_lshlrev_b32 v19, 4, v19
    v_xor_b32 v17, 0x0c0c, v17
    v_lshlrev_b32 v17, v19, v17
    v_xor_b32 v17, 0x0c0c0c0c, v17
    v_bfe_u32 v19, v0, 1, 2
v_cmp_eq_u32 vcc, 0, v19
    v_mov_b32 v4, 0x0c0c0c0c
    s_nop 0
    v_cndmask_b32 v4, v4, v17, vcc
v_cmp_eq_u32 vcc, 1, v19
    v_mov_b32 v5, 0x0c0c0c0c
    s_nop 0
    v_cndmask_b32 v5, v5, v17, vcc
v_cmp_eq_u32 vcc, 2, v19
    v_mov_b32 v6, 0x0c0c0c0c
    s_nop 0
    v_cndmask_b32 v6, v6, v17, vcc
v_cmp_eq_u32 vcc, 3, v19
    v_mov_b32 v7, 0x0c0c0c0c
    s_nop 0
    v_cndmask_b32 v7, v7, v17, vcc
v_mov_b32 v18, 0
v_add_u32 v17, 1, v18
    v_lshl_or_b32 v17, v17, 8, v18
    v_and_b32 v19, 1, v0
    v_lshlrev_b32 v19, 4, v19
    v_xor_b32 v17, 0x0c0c, v17
    v_lshlrev_b32 v17, v19, v17
    v_xor_b32 v17, 0x0c0c0c0c, v17
    v_bfe_u32 v19, v0, 1, 2
v_cmp_eq_u32 vcc, 0, v19
    v_mov_b32 v8, 0x0c0c0c0c
    s_nop 0
    v_cndmask_b32 v8, v8, v17, vcc
v_cmp_eq_u32 vcc, 1, v19
    v_mov_b32 v9, 0x0c0c0c0c
    s_nop 0
    v_cndmask_b32 v9, v9, v17, vcc
v_cmp_eq_u32 vcc, 2, v19
    v_mov_b32 v10, 0x0c0c0c0c
    s_nop 0
    v_cndmask_b32 v10, v10, v17, vcc
v_cmp_eq_u32 vcc, 3, v19
    v_mov_b32 v11, 0x0c0c0c0c
    s_nop 0
    v_cndmask_b32 v11, v11, v17, vcc
v_mov_b32 v18, 2
v_add_u32 v17, 1, v18
    v_lshl_or_b32 v17, v17, 8, v18
    v_and_b32 v19, 1, v0
    v_lshlrev_b32 v19, 4, v19
    v_xor_b32 v17, 0x0c0c, v17
    v_lshlrev_b32 v17, v19, v17
    v_xor_b32 v17, 0x0c0c0c0c, v17
    v_bfe_u32 v19, v0, 1, 2
v_cmp_eq_u32 vcc, 0, v19
    v_mov_b32 v120, 0x0c0c0c0c
    s_nop 0
    v_cndmask_b32 v120, v120, v17, vcc
v_cmp_eq_u32 vcc, 1, v19
    v_mov_b32 v121, 0x0c0c0c0c
    s_nop 0
    v_cndmask_b32 v121, v121, v17, vcc
v_cmp_eq_u32 vcc, 2, v19
    v_mov_b32 v122, 0x0c0c0c0c
    s_nop 0
    v_cndmask_b32 v122, v122, v17, vcc
v_cmp_eq_u32 vcc, 3, v19
    v_mov_b32 v123, 0x0c0c0c0c
    s_nop 0
    v_cndmask_b32 v123, v123, v17, vcc
v_add_u32 v17, 0, v1
    v_xor_b32 v17, v17, v2
    v_lshlrev_b32 v17, 4, v17
    v_lshl_add_u32 v17, v2, 10, v17
    v_add_u32 v12, s11, v17
v_add_u32 v17, 4, v1
    v_xor_b32 v17, v17, v2
    v_lshlrev_b32 v17, 4, v17
    v_lshl_add_u32 v17, v2, 10, v17
    v_add_u32 v13, s11, v17
v_add_u32 v17, 8, v1
    v_xor_b32 v17, v17, v2
    v_lshlrev_b32 v17, 4, v17
    v_lshl_add_u32 v17, v2, 10, v17
    v_add_u32 v14, s11, v17
v_add_u32 v17, 12, v1
    v_xor_b32 v17, v17, v2
    v_lshlrev_b32 v17, 4, v17
    v_lshl_add_u32 v17, v2, 10, v17
    v_add_u32 v15, s11, v17
v_xor_b32 v17, 0, v3
s_add_u32 m0, s11, 0
s_and_b32 s14, s10, 7168
s_add_u32 s14, s14, s8
s_add_u32 s10, s10, 1024
s_waitcnt vmcnt(2)
buffer_load_dwordx4 v17, s[48:51], s14 offen nt lds
v_xor_b32 v17, 16, v3
s_add_u32 m0, s11, 1024
s_and_b32 s14, s10, 7168
s_add_u32 s14, s14, s8
s_add_u32 s10, s10, 1024
s_waitcnt vmcnt(2)
buffer_load_dwordx4 v17, s[48:51], s14 offen nt lds
v_xor_b32 v17, 32, v3
s_add_u32 m0, s11, 2048
s_and_b32 s14, s10, 7168
s_add_u32 s14, s14, s8
s_add_u32 s10, s10, 1024
s_waitcnt vmcnt(2)
buffer_load_dwordx4 v17, s[48:51], s14 offen nt lds
v_lshlrev_b32 v18, 1, v1
v_add_u32 v17, 1, v18
    v_lshl_or_b32 v17, v17, 8, v18
    v_and_b32 v19, 1, v0
    v_lshlrev_b32 v19, 4, v19
    v_xor_b32 v17, 0x0c0c, v17
    v_lshlrev_b32 v17, v19, v17
    v_xor_b32 v17, 0x0c0c0c0c, v17
    v_bfe_u32 v19, v0, 1, 2
v_cmp_eq_u32 vcc, 0, v19
    v_mov_b32 v20, 0x0c0c0c0c
    s_nop 0
    v_cndmask_b32 v20, v20, v17, vcc
v_cmp_eq_u32 vcc, 1, v19
    v_mov_b32 v21, 0x0c0c0c0c
    s_nop 0
    v_cndmask_b32 v21, v21, v17, vcc
v_cmp_eq_u32 vcc, 2, v19
    v_mov_b32 v22, 0x0c0c0c0c
    s_nop 0
    v_cndmask_b32 v22, v22, v17, vcc
v_cmp_eq_u32 vcc, 3, v19
    v_mov_b32 v23, 0x0c0c0c0c
    s_nop 0
    v_cndmask_b32 v23, v23, v17, vcc
s_waitcnt lgkmcnt(0)
    s_add_u32 s4, s4, 1
v_mov_b32 v17, s64
v_perm_b32 v164, s65, v17, v20
v_perm_b32 v165, s65, v17, v21
v_perm_b32 v166, s65, v17, v22
v_perm_b32 v167, s65, v17, v23
v_mov_b32 v17, s66
v_perm_b32 v168, s67, v17, v20
v_perm_b32 v169, s67, v17, v21
v_perm_b32 v170, s67, v17, v22
v_perm_b32 v171, s67, v17, v23
v_mov_b32 v17, s68
v_perm_b32 v172, s69, v17, v20
v_perm_b32 v173, s69, v17, v21
v_perm_b32 v174, s69, v17, v22
v_perm_b32 v175, s69, v17, v23
v_mov_b32 v17, s70
v_perm_b32 v176, s71, v17, v20
v_perm_b32 v177, s71, v17, v21
v_perm_b32 v178, s71, v17, v22
v_perm_b32 v179, s71, v17, v23
v_mov_b32 v17, s72
v_perm_b32 v180, s73, v17, v20
v_perm_b32 v181, s73, v17, v21
v_perm_b32 v182, s73, v17, v22
v_perm_b32 v183, s73, v17, v23
v_mov_b32 v17, s74
v_perm_b32 v184, s75, v17, v20
v_perm_b32 v185, s75, v17, v21
v_perm_b32 v186, s75, v17, v22
v_perm_b32 v187, s75, v17, v23
v_mov_b32 v17, s76
v_perm_b32 v188, s77, v17, v20
v_perm_b32 v189, s77, v17, v21
v_perm_b32 v190, s77, v17, v22
v_perm_b32 v191, s77, v17, v23
v_mov_b32 v17, s78
v_perm_b32 v192, s79, v17, v20
v_perm_b32 v193, s79, v17, v21
v_perm_b32 v194, s79, v17, v22
v_perm_b32 v195, s79, v17, v23
v_mov_b32 v17, s80
v_perm_b32 v196, s81, v17, v20
v_perm_b32 v197, s81, v17, v21
v_perm_b32 v198, s81, v17, v22
v_perm_b32 v199, s81, v17, v23
s_waitcnt vmcnt(11)
v_mfma_f32_16x16x32_bf16 v[56:59], v[128:131], v[164:167], 0
s_waitcnt vmcnt(10)
v_mfma_f32_16x16x32_bf16 v[56:59], v[132:135], v[168:171], v[56:59]
s_waitcnt vmcnt(9)
v_mfma_f32_16x16x32_bf16 v[56:59], v[136:139], v[172:175], v[56:59]
s_waitcnt vmcnt(8)
v_mfma_f32_16x16x32_bf16 v[56:59], v[140:143], v[176:179], v[56:59]
s_waitcnt vmcnt(7)
v_mfma_f32_16x16x32_bf16 v[56:59], v[144:147], v[180:183], v[56:59]
s_waitcnt vmcnt(6)
v_mfma_f32_16x16x32_bf16 v[56:59], v[148:151], v[184:187], v[56:59]
s_waitcnt vmcnt(5)
v_mfma_f32_16x16x32_bf16 v[56:59], v[152:155], v[188:191], v[56:59]
s_waitcnt vmcnt(4)
v_mfma_f32_16x16x32_bf16 v[56:59], v[156:159], v[192:195], v[56:59]
s_waitcnt vmcnt(3)
v_mfma_f32_16x16x32_bf16 v[56:59], v[160:163], v[196:199], v[56:59]
v_lshl_add_u32 v17, s3, 10, v3
    v_add_u32 v17, 131072, v17
    s_nop 5
    ds_write_b128 v17, v[56:59]
    s_waitcnt lgkmcnt(0)
    s_barrier
v_xor_b32 v17, 48, v3
s_add_u32 m0, s11, 3072
s_and_b32 s14, s10, 7168
s_add_u32 s14, s14, s8
s_add_u32 s10, s10, 1024
s_waitcnt vmcnt(2)
buffer_load_dwordx4 v17, s[48:51], s14 offen nt lds
v_xor_b32 v17, 64, v3
s_add_u32 m0, s11, 4096
s_and_b32 s14, s10, 7168
s_add_u32 s14, s14, s8
s_add_u32 s10, s10, 1024
s_waitcnt vmcnt(3)
buffer_load_dwordx4 v17, s[48:51], s14 offen nt lds
v_xor_b32 v17, 80, v3
s_add_u32 m0, s11, 5120
s_and_b32 s14, s10, 7168
s_add_u32 s14, s14, s8
s_add_u32 s10, s10, 1024
s_waitcnt vmcnt(3)
buffer_load_dwordx4 v17, s[48:51], s14 offen nt lds
v_xor_b32 v17, 96, v3
s_add_u32 m0, s11, 6144
s_and_b32 s14, s10, 7168
s_add_u32 s14, s14, s8
s_add_u32 s10, s10, 1024
s_waitcnt vmcnt(3)
buffer_load_dwordx4 v17, s[48:51], s14 offen nt lds
v_xor_b32 v17, 112, v3
s_add_u32 m0, s11, 7168
s_and_b32 s14, s10, 7168
s_add_u32 s14, s14, s8
s_add_u32 s10, s10, 1024
s_waitcnt vmcnt(3)
buffer_load_dwordx4 v17, s[48:51], s14 offen nt lds
v_xor_b32 v17, 128, v3
s_add_u32 m0, s11, 8192
s_and_b32 s14, s10, 7168
s_add_u32 s14, s14, s8
s_add_u32 s14, s14, 262144
s_add_u32 s10, s10, 1024
s_waitcnt vmcnt(3)
buffer_load_dwordx4 v17, s[48:51], s14 offen nt lds
v_xor_b32 v17, 144, v3
s_add_u32 m0, s11, 9216
s_and_b32 s14, s10, 7168
s_add_u32 s14, s14, s8
s_add_u32 s14, s14, 262144
s_add_u32 s10, s10, 1024
s_waitcnt vmcnt(3)
buffer_load_dwordx4 v17, s[48:51], s14 offen nt lds
v_xor_b32 v17, 160, v3
s_add_u32 m0, s11, 10240
s_and_b32 s14, s10, 7168
s_add_u32 s14, s14, s8
s_add_u32 s14, s14, 262144
s_add_u32 s10, s10, 1024
s_waitcnt vmcnt(3)
buffer_load_dwordx4 v17, s[48:51], s14 offen nt lds
v_xor_b32 v17, 176, v3
s_add_u32 m0, s11, 11264
s_and_b32 s14, s10, 7168
s_add_u32 s14, s14, s8
s_add_u32 s14, s14, 262144
s_add_u32 s10, s10, 1024
s_waitcnt vmcnt(3)
buffer_load_dwordx4 v17, s[48:51], s14 offen nt lds
v_xor_b32 v17, 192, v3
s_add_u32 m0, s11, 12288
s_and_b32 s14, s10, 7168
s_add_u32 s14, s14, s8
s_add_u32 s14, s14, 262144
s_add_u32 s10, s10, 1024
s_waitcnt vmcnt(3)
buffer_load_dwordx4 v17, s[48:51], s14 offen nt lds
v_xor_b32 v17, 208, v3
s_add_u32 m0, s11, 13312
s_and_b32 s14, s10, 7168
s_add_u32 s14, s14, s8
s_add_u32 s14, s14, 262144
s_add_u32 s10, s10, 1024
s_waitcnt vmcnt(3)
buffer_load_dwordx4 v17, s[48:51], s14 offen nt lds
v_xor_b32 v17, 224, v3
s_add_u32 m0, s11, 14336
s_and_b32 s14, s10, 7168
s_add_u32 s14, s14, s8
s_add_u32 s14, s14, 262144
s_add_u32 s10, s10, 1024
s_waitcnt vmcnt(3)
buffer_load_dwordx4 v17, s[48:51], s14 offen nt lds
v_xor_b32 v17, 240, v3
s_add_u32 m0, s11, 15360
s_and_b32 s14, s10, 7168
s_add_u32 s14, s14, s8
s_add_u32 s14, s14, 262144
s_add_u32 s10, s10, 1024
s_waitcnt vmcnt(3)
buffer_load_dwordx4 v17, s[48:51], s14 offen nt lds
v_xor_b32 v17, 0, v3
s_add_u32 m0, s11, 16384
s_and_b32 s14, s10, 7168
s_add_u32 s14, s14, s8
s_add_u32 s14, s14, 524288
s_add_u32 s10, s10, 1024
s_waitcnt vmcnt(8)
buffer_load_dwordx4 v17, s[48:51], s14 offen nt lds
v_xor_b32 v17, 16, v3
s_add_u32 m0, s11, 17408
s_and_b32 s14, s10, 7168
s_add_u32 s14, s14, s8
s_add_u32 s14, s14, 524288
s_add_u32 s10, s10, 1024
s_waitcnt vmcnt(8)
buffer_load_dwordx4 v17, s[48:51], s14 offen nt lds
v_xor_b32 v17, 32, v3
s_add_u32 m0, s11, 18432
s_and_b32 s14, s10, 7168
s_add_u32 s14, s14, s8
s_add_u32 s14, s14, 524288
s_add_u32 s10, s10, 1024
s_waitcnt vmcnt(8)
buffer_load_dwordx4 v17, s[48:51], s14 offen nt lds
v_xor_b32 v17, 48, v3
s_add_u32 m0, s11, 19456
s_and_b32 s14, s10, 7168
s_add_u32 s14, s14, s8
s_add_u32 s14, s14, 524288
s_add_u32 s10, s10, 1024
s_waitcnt vmcnt(8)
buffer_load_dwordx4 v17, s[48:51], s14 offen nt lds
v_xor_b32 v17, 64, v3
s_add_u32 m0, s11, 20480
s_and_b32 s14, s10, 7168
s_add_u32 s14, s14, s8
s_add_u32 s14, s14, 524288
s_add_u32 s10, s10, 1024
s_waitcnt vmcnt(8)
buffer_load_dwordx4 v17, s[48:51], s14 offen nt lds
v_xor_b32 v17, 80, v3
s_add_u32 m0, s11, 21504
s_and_b32 s14, s10, 7168
s_add_u32 s14, s14, s8
s_add_u32 s14, s14, 524288
s_add_u32 s10, s10, 1024
s_waitcnt vmcnt(8)
buffer_load_dwordx4 v17, s[48:51], s14 offen nt lds
v_xor_b32 v17, 96, v3
s_add_u32 m0, s11, 22528
s_and_b32 s14, s10, 7168
s_add_u32 s14, s14, s8
s_add_u32 s14, s14, 524288
s_add_u32 s10, s10, 1024
s_waitcnt vmcnt(8)
buffer_load_dwordx4 v17, s[48:51], s14 offen nt lds
v_xor_b32 v17, 112, v3
s_add_u32 m0, s11, 23552
s_and_b32 s14, s10, 7168
s_add_u32 s14, s14, s8
s_add_u32 s14, s14, 524288
s_add_u32 s10, s10, 1024
s_waitcnt vmcnt(8)
buffer_load_dwordx4 v17, s[48:51], s14 offen nt lds
v_xor_b32 v17, 128, v3
s_add_u32 m0, s11, 24576
s_and_b32 s14, s10, 7168
s_add_u32 s14, s14, s8
s_add_u32 s14, s14, 786432
s_add_u32 s10, s10, 1024
s_waitcnt vmcnt(8)
buffer_load_dwordx4 v17, s[48:51], s14 offen nt lds
v_xor_b32 v17, 144, v3
s_add_u32 m0, s11, 25600
s_and_b32 s14, s10, 7168
s_add_u32 s14, s14, s8
s_add_u32 s14, s14, 786432
s_add_u32 s10, s10, 1024
s_waitcnt vmcnt(8)
buffer_load_dwordx4 v17, s[48:51], s14 offen nt lds
v_xor_b32 v17, 160, v3
s_add_u32 m0, s11, 26624
s_and_b32 s14, s10, 7168
s_add_u32 s14, s14, s8
s_add_u32 s14, s14, 786432
s_add_u32 s10, s10, 1024
s_waitcnt vmcnt(8)
buffer_load_dwordx4 v17, s[48:51], s14 offen nt lds
v_xor_b32 v17, 176, v3
s_add_u32 m0, s11, 27648
s_and_b32 s14, s10, 7168
s_add_u32 s14, s14, s8
s_add_u32 s14, s14, 786432
s_add_u32 s10, s10, 1024
s_waitcnt vmcnt(8)
buffer_load_dwordx4 v17, s[48:51], s14 offen nt lds
v_xor_b32 v17, 192, v3
s_add_u32 m0, s11, 28672
s_and_b32 s14, s10, 7168
s_add_u32 s14, s14, s8
s_add_u32 s14, s14, 786432
s_add_u32 s10, s10, 1024
s_waitcnt vmcnt(8)
buffer_load_dwordx4 v17, s[48:51], s14 offen nt lds
v_xor_b32 v17, 208, v3
s_add_u32 m0, s11, 29696
s_and_b32 s14, s10, 7168
s_add_u32 s14, s14, s8
s_add_u32 s14, s14, 786432
s_add_u32 s10, s10, 1024
s_waitcnt vmcnt(8)
buffer_load_dwordx4 v17, s[48:51], s14 offen nt lds
v_xor_b32 v17, 224, v3
s_add_u32 m0, s11, 30720
s_and_b32 s14, s10, 7168
s_add_u32 s14, s14, s8
s_add_u32 s14, s14, 786432
s_add_u32 s10, s10, 1024
s_waitcnt vmcnt(8)
buffer_load_dwordx4 v17, s[48:51], s14 offen nt lds
v_xor_b32 v17, 240, v3
s_add_u32 m0, s11, 31744
s_and_b32 s14, s10, 7168
s_add_u32 s14, s14, s8
s_add_u32 s14, s14, 786432
s_add_u32 s10, s10, 1024
s_waitcnt vmcnt(8)
buffer_load_dwordx4 v17, s[48:51], s14 offen nt lds
s_and_b32 s12, s10, 7168
s_add_u32 s12, s12, s8
s_add_u32 s10, s10, 1024
s_waitcnt vmcnt(8)
buffer_load_dwordx4 v[128:131], v3, s[52:55], s12 offen nt
s_and_b32 s12, s10, 7168
s_add_u32 s12, s12, s8
s_add_u32 s10, s10, 1024
s_waitcnt vmcnt(8)
buffer_load_dwordx4 v[132:135], v3, s[52:55], s12 offen nt
s_and_b32 s12, s10, 7168
s_add_u32 s12, s12, s8
s_add_u32 s10, s10, 1024
s_waitcnt vmcnt(8)
buffer_load_dwordx4 v[136:139], v3, s[52:55], s12 offen nt
s_and_b32 s12, s10, 7168
s_add_u32 s12, s12, s8
s_add_u32 s10, s10, 1024
s_waitcnt vmcnt(8)
buffer_load_dwordx4 v[140:143], v3, s[52:55], s12 offen nt
s_and_b32 s12, s10, 7168
s_add_u32 s12, s12, s8
s_add_u32 s10, s10, 1024
s_waitcnt vmcnt(8)
buffer_load_dwordx4 v[144:147], v3, s[52:55], s12 offen nt
s_and_b32 s12, s10, 7168
s_add_u32 s12, s12, s8
s_add_u32 s10, s10, 1024
s_waitcnt vmcnt(8)
buffer_load_dwordx4 v[148:151], v3, s[52:55], s12 offen nt
s_and_b32 s12, s10, 7168
s_add_u32 s12, s12, s8
s_add_u32 s10, s10, 1024
s_waitcnt vmcnt(8)
buffer_load_dwordx4 v[152:155], v3, s[52:55], s12 offen nt
s_and_b32 s12, s10, 7168
s_add_u32 s12, s12, s8
s_add_u32 s10, s10, 1024
s_waitcnt vmcnt(8)
buffer_load_dwordx4 v[156:159], v3, s[52:55], s12 offen nt
s_and_b32 s12, s10, 7168
s_add_u32 s12, s12, s8
s_add_u32 s12, s12, 262144
s_add_u32 s10, s10, 1024
s_waitcnt vmcnt(8)
buffer_load_dwordx4 v[160:163], v3, s[52:55], s12 offen nt
s_waitcnt vmcnt(9)
s_barrier
v_and_b32 v17, 1, v0
    v_lshlrev_b32 v17, 8, v17
    v_lshl_add_u32 v17, v1, 4, v17
    v_add_u32 v17, 147712, v17
    v_cmp_eq_u32 s[64:65], 1, v1
    v_cmp_eq_u32 s[66:67], 2, v1
    v_cmp_eq_u32 s[68:69], 3, v1
ds_read_b128 v[20:23], v17 offset:0
ds_read_b128 v[24:27], v17 offset:64
ds_read_b128 v[28:31], v17 offset:128
ds_read_b128 v[32:35], v17 offset:192
ds_read_b128 v[36:39], v12 offset:0
ds_read_b128 v[40:43], v13 offset:0
ds_read_b128 v[44:47], v14 offset:0
ds_read_b128 v[48:51], v15 offset:0
ds_read_b128 v[52:55], v12 offset:256
s_waitcnt lgkmcnt(4)
v_mfma_f32_16x16x32_bf16 v[56:59], v[20:23], v[36:39], 0
ds_read_b128 v[36:39], v13 offset:256
s_waitcnt lgkmcnt(4)
v_mfma_f32_16x16x32_bf16 v[56:59], v[24:27], v[40:43], v[56:59]
ds_read_b128 v[40:43], v14 offset:256
s_waitcnt lgkmcnt(4)
v_mfma_f32_16x16x32_bf16 v[56:59], v[28:31], v[44:47], v[56:59]
ds_read_b128 v[44:47], v15 offset:256
s_waitcnt lgkmcnt(4)
v_mfma_f32_16x16x32_bf16 v[56:59], v[32:35], v[48:51], v[56:59]
s_and_b32 s12, s10, 7168
s_add_u32 s12, s12, s8
s_add_u32 s12, s12, 262144
s_add_u32 s10, s10, 1024
s_waitcnt vmcnt(8)
buffer_load_dwordx4 v[164:167], v3, s[52:55], s12 offen nt
ds_read_b128 v[48:51], v12 offset:512
s_waitcnt lgkmcnt(4)
v_mfma_f32_16x16x32_bf16 v[60:63], v[20:23], v[52:55], 0
ds_read_b128 v[52:55], v13 offset:512
s_waitcnt lgkmcnt(4)
v_mfma_f32_16x16x32_bf16 v[60:63], v[24:27], v[36:39], v[60:63]
ds_read_b128 v[36:39], v14 offset:512
s_waitcnt lgkmcnt(4)
v_mfma_f32_16x16x32_bf16 v[60:63], v[28:31], v[40:43], v[60:63]
ds_read_b128 v[40:43], v15 offset:512
s_waitcnt lgkmcnt(4)
v_mfma_f32_16x16x32_bf16 v[60:63], v[32:35], v[44:47], v[60:63]
s_and_b32 s12, s10, 7168
s_add_u32 s12, s12, s8
s_add_u32 s12, s12, 262144
s_add_u32 s10, s10, 1024
s_waitcnt vmcnt(8)
buffer_load_dwordx4 v[168:171], v3, s[52:55], s12 offen nt
ds_read_b128 v[44:47], v12 offset:768
s_waitcnt lgkmcnt(4)
v_mfma_f32_16x16x32_bf16 v[64:67], v[20:23], v[48:51], 0
ds_read_b128 v[48:51], v13 offset:768
s_waitcnt lgkmcnt(4)
v_mfma_f32_16x16x32_bf16 v[64:67], v[24:27], v[52:55], v[64:67]
ds_read_b128 v[52:55], v14 offset:768
s_waitcnt lgkmcnt(4)
v_mfma_f32_16x16x32_bf16 v[64:67], v[28:31], v[36:39], v[64:67]
ds_read_b128 v[36:39], v15 offset:768
s_waitcnt lgkmcnt(4)
v_mfma_f32_16x16x32_bf16 v[64:67], v[32:35], v[40:43], v[64:67]
s_and_b32 s12, s10, 7168
s_add_u32 s12, s12, s8
s_add_u32 s12, s12, 262144
s_add_u32 s10, s10, 1024
s_waitcnt vmcnt(8)
buffer_load_dwordx4 v[172:175], v3, s[52:55], s12 offen nt
s_waitcnt lgkmcnt(3)
v_mfma_f32_16x16x32_bf16 v[68:71], v[20:23], v[44:47], 0
s_waitcnt lgkmcnt(2)
v_mfma_f32_16x16x32_bf16 v[68:71], v[24:27], v[48:51], v[68:71]
s_waitcnt lgkmcnt(1)
v_mfma_f32_16x16x32_bf16 v[68:71], v[28:31], v[52:55], v[68:71]
s_waitcnt lgkmcnt(0)
v_mfma_f32_16x16x32_bf16 v[68:71], v[32:35], v[36:39], v[68:71]
s_and_b32 s12, s10, 7168
s_add_u32 s12, s12, s8
s_add_u32 s12, s12, 262144
s_add_u32 s10, s10, 1024
s_waitcnt vmcnt(8)
buffer_load_dwordx4 v[176:179], v3, s[52:55], s12 offen nt
v_cndmask_b32 v72, v56, v60, s[64:65]
v_cndmask_b32 v72, v72, v64, s[66:67]
v_cndmask_b32 v72, v72, v68, s[68:69]
v_cndmask_b32 v73, v57, v61, s[64:65]
v_cndmask_b32 v73, v73, v65, s[66:67]
v_cndmask_b32 v73, v73, v69, s[68:69]
s_and_b32 s12, s10, 7168
s_add_u32 s12, s12, s8
s_add_u32 s12, s12, 262144
s_add_u32 s10, s10, 1024
s_waitcnt vmcnt(8)
buffer_load_dwordx4 v[180:183], v3, s[52:55], s12 offen nt
ds_read_b128 v[36:39], v12 offset:16384
ds_read_b128 v[40:43], v13 offset:16384
ds_read_b128 v[44:47], v14 offset:16384
ds_read_b128 v[48:51], v15 offset:16384
ds_read_b128 v[52:55], v12 offset:16640
s_waitcnt lgkmcnt(4)
v_mfma_f32_16x16x32_bf16 v[56:59], v[20:23], v[36:39], 0
ds_read_b128 v[36:39], v13 offset:16640
s_waitcnt lgkmcnt(4)
v_mfma_f32_16x16x32_bf16 v[56:59], v[24:27], v[40:43], v[56:59]
ds_read_b128 v[40:43], v14 offset:16640
s_waitcnt lgkmcnt(4)
v_mfma_f32_16x16x32_bf16 v[56:59], v[28:31], v[44:47], v[56:59]
ds_read_b128 v[44:47], v15 offset:16640
s_waitcnt lgkmcnt(4)
v_mfma_f32_16x16x32_bf16 v[56:59], v[32:35], v[48:51], v[56:59]
s_and_b32 s12, s10, 7168
s_add_u32 s12, s12, s8
s_add_u32 s12, s12, 262144
s_add_u32 s10, s10, 1024
s_waitcnt vmcnt(8)
buffer_load_dwordx4 v[184:187], v3, s[52:55], s12 offen nt
ds_read_b128 v[48:51], v12 offset:16896
s_waitcnt lgkmcnt(4)
v_mfma_f32_16x16x32_bf16 v[60:63], v[20:23], v[52:55], 0
ds_read_b128 v[52:55], v13 offset:16896
s_waitcnt lgkmcnt(4)
v_mfma_f32_16x16x32_bf16 v[60:63], v[24:27], v[36:39], v[60:63]
ds_read_b128 v[36:39], v14 offset:16896
s_waitcnt lgkmcnt(4)
v_mfma_f32_16x16x32_bf16 v[60:63], v[28:31], v[40:43], v[60:63]
ds_read_b128 v[40:43], v15 offset:16896
s_waitcnt lgkmcnt(4)
v_mfma_f32_16x16x32_bf16 v[60:63], v[32:35], v[44:47], v[60:63]
s_and_b32 s12, s10, 7168
s_add_u32 s12, s12, s8
s_add_u32 s12, s12, 262144
s_add_u32 s10, s10, 1024
s_waitcnt vmcnt(8)
buffer_load_dwordx4 v[188:191], v3, s[52:55], s12 offen nt
ds_read_b128 v[44:47], v12 offset:17152
s_waitcnt lgkmcnt(4)
v_mfma_f32_16x16x32_bf16 v[64:67], v[20:23], v[48:51], 0
ds_read_b128 v[48:51], v13 offset:17152
s_waitcnt lgkmcnt(4)
v_mfma_f32_16x16x32_bf16 v[64:67], v[24:27], v[52:55], v[64:67]
ds_read_b128 v[52:55], v14 offset:17152
s_waitcnt lgkmcnt(4)
v_mfma_f32_16x16x32_bf16 v[64:67], v[28:31], v[36:39], v[64:67]
ds_read_b128 v[36:39], v15 offset:17152
s_waitcnt lgkmcnt(4)
v_mfma_f32_16x16x32_bf16 v[64:67], v[32:35], v[40:43], v[64:67]
s_and_b32 s12, s10, 7168
s_add_u32 s12, s12, s8
s_add_u32 s12, s12, 524288
s_add_u32 s10, s10, 1024
s_waitcnt vmcnt(8)
buffer_load_dwordx4 v[192:195], v3, s[52:55], s12 offen nt
s_waitcnt lgkmcnt(3)
v_mfma_f32_16x16x32_bf16 v[68:71], v[20:23], v[44:47], 0
s_waitcnt lgkmcnt(2)
v_mfma_f32_16x16x32_bf16 v[68:71], v[24:27], v[48:51], v[68:71]
s_waitcnt lgkmcnt(1)
v_mfma_f32_16x16x32_bf16 v[68:71], v[28:31], v[52:55], v[68:71]
s_waitcnt lgkmcnt(0)
v_mfma_f32_16x16x32_bf16 v[68:71], v[32:35], v[36:39], v[68:71]
s_and_b32 s12, s10, 7168
s_add_u32 s12, s12, s8
s_add_u32 s12, s12, 524288
s_add_u32 s10, s10, 1024
s_waitcnt vmcnt(8)
buffer_load_dwordx4 v[196:199], v3, s[52:55], s12 offen nt
v_cndmask_b32 v74, v56, v60, s[64:65]
v_cndmask_b32 v74, v74, v64, s[66:67]
v_cndmask_b32 v74, v74, v68, s[68:69]
v_cndmask_b32 v75, v57, v61, s[64:65]
v_cndmask_b32 v75, v75, v65, s[66:67]
v_cndmask_b32 v75, v75, v69, s[68:69]
s_and_b32 s12, s10, 7168
s_add_u32 s12, s12, s8
s_add_u32 s12, s12, 524288
s_add_u32 s10, s10, 1024
s_waitcnt vmcnt(8)
buffer_load_dwordx4 v[200:203], v3, s[52:55], s12 offen nt
v_max_f32 v78, v72, v74
    v_max_f32 v79, v73, v75
    s_nop 0
v_max_f32_dpp v78, v78, v78 row_ror:8 row_mask:0xf bank_mask:0xf
v_max_f32_dpp v79, v79, v79 row_ror:8 row_mask:0xf bank_mask:0xf
    s_nop 0
v_max_f32_dpp v78, v78, v78 row_ror:4 row_mask:0xf bank_mask:0xf
v_max_f32_dpp v79, v79, v79 row_ror:4 row_mask:0xf bank_mask:0xf
    s_nop 0
v_max_f32_dpp v78, v78, v78 row_ror:2 row_mask:0xf bank_mask:0xf
v_max_f32_dpp v79, v79, v79 row_ror:2 row_mask:0xf bank_mask:0xf
    s_nop 0
v_max_f32_dpp v78, v78, v78 row_ror:1 row_mask:0xf bank_mask:0xf
v_max_f32_dpp v79, v79, v79 row_ror:1 row_mask:0xf bank_mask:0xf
s_and_b32 s12, s10, 7168
s_add_u32 s12, s12, s8
s_add_u32 s12, s12, 524288
s_add_u32 s10, s10, 1024
s_waitcnt vmcnt(8)
buffer_load_dwordx4 v[204:207], v3, s[52:55], s12 offen nt
v_lshl_add_u32 v17, s3, 2, v1
    v_lshlrev_b32 v17, 3, v17
    v_add_u32 v18, 148224, v17
    v_lshlrev_b32 v19, 3, v2
    v_add_u32 v19, 148224, v19
    s_mov_b32 exec_lo, 0x00010001
    s_mov_b32 exec_hi, 0x00010001
    ds_write_b64 v18, v[78:79]
    s_mov_b64 exec, -1
    s_waitcnt lgkmcnt(0)
    s_barrier
    ds_read_b64 v[78:79], v19
s_and_b32 s12, s10, 7168
s_add_u32 s12, s12, s8
s_add_u32 s12, s12, 524288
s_add_u32 s10, s10, 1024
s_waitcnt vmcnt(8)
buffer_load_dwordx4 v[208:211], v3, s[52:55], s12 offen nt
s_mov_b32 s14, 1040356334
    s_waitcnt lgkmcnt(0)
v_max_f32_dpp v78, v78, v78 row_ror:8 row_mask:0xf bank_mask:0xf
v_max_f32_dpp v79, v79, v79 row_ror:8 row_mask:0xf bank_mask:0xf
    s_nop 0
v_max_f32_dpp v78, v78, v78 row_ror:4 row_mask:0xf bank_mask:0xf
v_max_f32_dpp v79, v79, v79 row_ror:4 row_mask:0xf bank_mask:0xf
    s_nop 0
v_max_f32_dpp v78, v78, v78 row_ror:2 row_mask:0xf bank_mask:0xf
v_max_f32_dpp v79, v79, v79 row_ror:2 row_mask:0xf bank_mask:0xf
    s_nop 0
v_max_f32_dpp v78, v78, v78 row_ror:1 row_mask:0xf bank_mask:0xf
v_max_f32_dpp v79, v79, v79 row_ror:1 row_mask:0xf bank_mask:0xf
v_mul_f32 v78, s14, v78
    v_mul_f32 v79, s14, v79
v_fma_f32 v72, v72, s14, -v78
v_fma_f32 v73, v73, s14, -v79
v_fma_f32 v74, v74, s14, -v78
v_fma_f32 v75, v75, s14, -v79
v_exp_f32 v72, v72
v_exp_f32 v73, v73
v_exp_f32 v74, v74
v_exp_f32 v75, v75
s_and_b32 s12, s10, 7168
s_add_u32 s12, s12, s8
s_add_u32 s12, s12, 524288
s_add_u32 s10, s10, 1024
s_waitcnt vmcnt(8)
buffer_load_dwordx4 v[212:215], v3, s[52:55], s12 offen nt
v_cvt_pk_bf16_f32 v76, v72, v73
    v_cvt_pk_bf16_f32 v77, v74, v75
    v_add_f32 v80, v72, v74
    v_add_f32 v81, v73, v75
    s_nop 0
v_add_f32_dpp v80, v80, v80 row_ror:8 row_mask:0xf bank_mask:0xf
v_add_f32_dpp v81, v81, v81 row_ror:8 row_mask:0xf bank_mask:0xf
    s_nop 0
v_add_f32_dpp v80, v80, v80 row_ror:4 row_mask:0xf bank_mask:0xf
v_add_f32_dpp v81, v81, v81 row_ror:4 row_mask:0xf bank_mask:0xf
    s_nop 0
v_add_f32_dpp v80, v80, v80 row_ror:2 row_mask:0xf bank_mask:0xf
v_add_f32_dpp v81, v81, v81 row_ror:2 row_mask:0xf bank_mask:0xf
    s_nop 0
v_add_f32_dpp v80, v80, v80 row_ror:1 row_mask:0xf bank_mask:0xf
v_add_f32_dpp v81, v81, v81 row_ror:1 row_mask:0xf bank_mask:0xf
s_mov_b32 exec_lo, 0x00010001
    s_mov_b32 exec_hi, 0x00010001
    ds_write_b64 v18, v[80:81] offset:128
    s_mov_b64 exec, -1
s_and_b32 s12, s10, 7168
s_add_u32 s12, s12, s8
s_add_u32 s12, s12, 524288
s_add_u32 s10, s10, 1024
s_waitcnt vmcnt(8)
buffer_load_dwordx4 v[216:219], v3, s[52:55], s12 offen nt
v_and_b32 v124, 7, v0
    v_lshl_add_u32 v124, v1, 3, v124
    v_lshlrev_b32 v124, 4, v124
    v_lshl_add_u32 v124, s3, 9, v124
s_sub_u32 s71, s2, 128
    s_lshl_b32 s70, s71, 11
    s_add_u32 s70, s70, 1048576
    s_add_u32 s68, s70, 1024
    v_add_u32 v15, 148480, v3
    v_lshl_add_u32 v14, s3, 10, v15
    s_mul_i32 s71, s71, 2304
    s_add_u32 s71, s71, 2752512
    s_lshl_b32 s5, s6, 14
    s_add_u32 s5, s5, 1048576
    s_lshr_b32 s69, s7, 2
    s_and_b32 s67, s7, 3
    s_lshl_b32 s67, s67, 1
    s_add_u32 s67, s67, s69
    s_lshl_b32 s67, s67, 7
    s_lshl_b32 s69, s69, 4
    s_add_u32 s69, s69, 1024
    v_and_b32 v36, 7, v0
    v_lshlrev_b32 v36, 11, v36
    v_add_u32 v13, s69, v36
    v_lshrrev_b32 v37, 3, v0
    v_lshl_add_u32 v36, v37, 4, v36
    v_add_u32 v12, s67, v36
    s_bitcmp1_b32 s3, 1
    s_cselect_b64 s[64:65], -1, 0
    s_bitcmp1_b32 s3, 0
    s_cselect_b32 s67, 0, 16
    s_waitcnt lgkmcnt(0)
    s_barrier
    s_cmp_lg_u32 s3, 0
    s_cbranch_scc1 L_Bnostat
    ds_read_b64 v[80:81], v19 offset:128
    v_and_b32 v56, 1, v0
    v_cmp_eq_u32 vcc, 1, v56
    s_waitcnt lgkmcnt(0)
v_add_f32_dpp v80, v80, v80 row_ror:8 row_mask:0xf bank_mask:0xf
v_add_f32_dpp v81, v81, v81 row_ror:8 row_mask:0xf bank_mask:0xf
    s_nop 0
v_add_f32_dpp v80, v80, v80 row_ror:4 row_mask:0xf bank_mask:0xf
v_add_f32_dpp v81, v81, v81 row_ror:4 row_mask:0xf bank_mask:0xf
    s_nop 0
v_add_f32_dpp v80, v80, v80 row_ror:2 row_mask:0xf bank_mask:0xf
v_add_f32_dpp v81, v81, v81 row_ror:2 row_mask:0xf bank_mask:0xf
    s_nop 0
v_add_f32_dpp v80, v80, v80 row_ror:1 row_mask:0xf bank_mask:0xf
v_add_f32_dpp v81, v81, v81 row_ror:1 row_mask:0xf bank_mask:0xf
v_cndmask_b32 v60, v78, v79, vcc
    v_mov_b32 v61, s4
    v_cndmask_b32 v62, v80, v81, vcc
    v_mov_b32 v63, s4
    s_mov_b64 exec, 0xff
    buffer_store_dwordx4 v[60:63], v3, s[44:47], s68 offen sc1
    s_mov_b64 exec, -1
L_Bnostat:
s_and_b32 s12, s10, 7168
s_add_u32 s12, s12, s8
s_add_u32 s12, s12, 524288
s_add_u32 s10, s10, 1024
s_waitcnt vmcnt(8)
buffer_load_dwordx4 v[220:223], v3, s[52:55], s12 offen nt
v_mov_b32_dpp v17, v76 row_newbcast:0 row_mask:0xf bank_mask:0xf
v_perm_b32 v20, v17, v17, v4
v_perm_b32 v21, v17, v17, v5
v_perm_b32 v22, v17, v17, v6
v_perm_b32 v23, v17, v17, v7
s_and_b32 s12, s10, 7168
s_add_u32 s12, s12, s8
s_add_u32 s12, s12, 786432
s_add_u32 s10, s10, 1024
s_waitcnt vmcnt(8)
buffer_load_dwordx4 v[224:227], v3, s[52:55], s12 offen nt
v_mov_b32_dpp v17, v76 row_newbcast:1 row_mask:0xf bank_mask:0xf
v_perm_b32 v24, v17, v17, v4
v_perm_b32 v25, v17, v17, v5
v_perm_b32 v26, v17, v17, v6
v_perm_b32 v27, v17, v17, v7
s_waitcnt vmcnt(24)
v_mfma_f32_16x16x32_bf16 v[84:87], v[128:131], v[20:23], 0
v_mov_b32_dpp v17, v76 row_newbcast:2 row_mask:0xf bank_mask:0xf
v_perm_b32 v20, v17, v17, v4
v_perm_b32 v21, v17, v17, v5
v_perm_b32 v22, v17, v17, v6
v_perm_b32 v23, v17, v17, v7
s_waitcnt vmcnt(23)
v_mfma_f32_16x16x32_bf16 v[84:87], v[132:135], v[24:27], v[84:87]
s_and_b32 s12, s10, 7168
s_add_u32 s12, s12, s8
s_add_u32 s12, s12, 786432
s_add_u32 s10, s10, 1024
s_waitcnt vmcnt(8)
buffer_load_dwordx4 v[228:231], v3, s[52:55], s12 offen nt
v_mov_b32_dpp v17, v76 row_newbcast:3 row_mask:0xf bank_mask:0xf
v_perm_b32 v24, v17, v17, v4
v_perm_b32 v25, v17, v17, v5
v_perm_b32 v26, v17, v17, v6
v_perm_b32 v27, v17, v17, v7
s_waitcnt vmcnt(23)
v_mfma_f32_16x16x32_bf16 v[84:87], v[136:139], v[20:23], v[84:87]
v_mov_b32_dpp v17, v76 row_newbcast:4 row_mask:0xf bank_mask:0xf
v_perm_b32 v20, v17, v17, v4
v_perm_b32 v21, v17, v17, v5
v_perm_b32 v22, v17, v17, v6
v_perm_b32 v23, v17, v17, v7
s_waitcnt vmcnt(22)
v_mfma_f32_16x16x32_bf16 v[84:87], v[140:143], v[24:27], v[84:87]
s_and_b32 s12, s10, 7168
s_add_u32 s12, s12, s8
s_add_u32 s12, s12, 786432
s_add_u32 s10, s10, 1024
s_waitcnt vmcnt(8)
buffer_load_dwordx4 v[232:235], v3, s[52:55], s12 offen nt
v_mov_b32_dpp v17, v76 row_newbcast:5 row_mask:0xf bank_mask:0xf
v_perm_b32 v24, v17, v17, v4
v_perm_b32 v25, v17, v17, v5
v_perm_b32 v26, v17, v17, v6
v_perm_b32 v27, v17, v17, v7
s_waitcnt vmcnt(22)
v_mfma_f32_16x16x32_bf16 v[84:87], v[144:147], v[20:23], v[84:87]
v_mov_b32_dpp v17, v76 row_newbcast:6 row_mask:0xf bank_mask:0xf
v_perm_b32 v20, v17, v17, v4
v_perm_b32 v21, v17, v17, v5
v_perm_b32 v22, v17, v17, v6
v_perm_b32 v23, v17, v17, v7
s_waitcnt vmcnt(21)
v_mfma_f32_16x16x32_bf16 v[84:87], v[148:151], v[24:27], v[84:87]
s_and_b32 s12, s10, 7168
s_add_u32 s12, s12, s8
s_add_u32 s12, s12, 786432
s_add_u32 s10, s10, 1024
s_waitcnt vmcnt(8)
buffer_load_dwordx4 v[236:239], v3, s[52:55], s12 offen nt
v_mov_b32_dpp v17, v76 row_newbcast:7 row_mask:0xf bank_mask:0xf
v_perm_b32 v24, v17, v17, v4
v_perm_b32 v25, v17, v17, v5
v_perm_b32 v26, v17, v17, v6
v_perm_b32 v27, v17, v17, v7
s_waitcnt vmcnt(21)
v_mfma_f32_16x16x32_bf16 v[84:87], v[152:155], v[20:23], v[84:87]
v_mov_b32_dpp v17, v76 row_newbcast:8 row_mask:0xf bank_mask:0xf
v_perm_b32 v20, v17, v17, v4
v_perm_b32 v21, v17, v17, v5
v_perm_b32 v22, v17, v17, v6
v_perm_b32 v23, v17, v17, v7
s_waitcnt vmcnt(20)
v_mfma_f32_16x16x32_bf16 v[84:87], v[156:159], v[24:27], v[84:87]
s_and_b32 s12, s10, 7168
s_add_u32 s12, s12, s8
s_add_u32 s12, s12, 786432
s_add_u32 s10, s10, 1024
s_waitcnt vmcnt(8)
buffer_load_dwordx4 v[240:243], v3, s[52:55], s12 offen nt
v_mov_b32_dpp v17, v76 row_newbcast:9 row_mask:0xf bank_mask:0xf
v_perm_b32 v24, v17, v17, v4
v_perm_b32 v25, v17, v17, v5
v_perm_b32 v26, v17, v17, v6
v_perm_b32 v27, v17, v17, v7
s_waitcnt vmcnt(20)
v_mfma_f32_16x16x32_bf16 v[84:87], v[160:163], v[20:23], v[84:87]
v_mov_b32_dpp v17, v76 row_newbcast:10 row_mask:0xf bank_mask:0xf
v_perm_b32 v20, v17, v17, v4
v_perm_b32 v21, v17, v17, v5
v_perm_b32 v22, v17, v17, v6
v_perm_b32 v23, v17, v17, v7
s_waitcnt vmcnt(19)
v_mfma_f32_16x16x32_bf16 v[84:87], v[164:167], v[24:27], v[84:87]
s_and_b32 s12, s10, 7168
s_add_u32 s12, s12, s8
s_add_u32 s12, s12, 786432
s_add_u32 s10, s10, 1024
s_waitcnt vmcnt(8)
buffer_load_dwordx4 v[244:247], v3, s[52:55], s12 offen nt
v_mov_b32_dpp v17, v76 row_newbcast:11 row_mask:0xf bank_mask:0xf
v_perm_b32 v24, v17, v17, v4
v_perm_b32 v25, v17, v17, v5
v_perm_b32 v26, v17, v17, v6
v_perm_b32 v27, v17, v17, v7
s_waitcnt vmcnt(19)
v_mfma_f32_16x16x32_bf16 v[84:87], v[168:171], v[20:23], v[84:87]
v_mov_b32_dpp v17, v76 row_newbcast:12 row_mask:0xf bank_mask:0xf
v_perm_b32 v20, v17, v17, v4
v_perm_b32 v21, v17, v17, v5
v_perm_b32 v22, v17, v17, v6
v_perm_b32 v23, v17, v17, v7
s_waitcnt vmcnt(18)
v_mfma_f32_16x16x32_bf16 v[84:87], v[172:175], v[24:27], v[84:87]
s_and_b32 s12, s10, 7168
s_add_u32 s12, s12, s8
s_add_u32 s12, s12, 786432
s_add_u32 s10, s10, 1024
s_waitcnt vmcnt(8)
buffer_load_dwordx4 v[248:251], v3, s[52:55], s12 offen nt
v_mov_b32_dpp v17, v76 row_newbcast:13 row_mask:0xf bank_mask:0xf
v_perm_b32 v24, v17, v17, v4
v_perm_b32 v25, v17, v17, v5
v_perm_b32 v26, v17, v17, v6
v_perm_b32 v27, v17, v17, v7
s_waitcnt vmcnt(18)
v_mfma_f32_16x16x32_bf16 v[84:87], v[176:179], v[20:23], v[84:87]
v_mov_b32_dpp v17, v76 row_newbcast:14 row_mask:0xf bank_mask:0xf
v_perm_b32 v20, v17, v17, v4
v_perm_b32 v21, v17, v17, v5
v_perm_b32 v22, v17, v17, v6
v_perm_b32 v23, v17, v17, v7
s_waitcnt vmcnt(17)
v_mfma_f32_16x16x32_bf16 v[84:87], v[180:183], v[24:27], v[84:87]
s_and_b32 s12, s10, 7168
s_add_u32 s12, s12, s8
s_add_u32 s12, s12, 786432
s_add_u32 s10, s10, 1024
s_waitcnt vmcnt(8)
buffer_load_dwordx4 v[252:255], v3, s[52:55], s12 offen nt
v_mov_b32_dpp v17, v76 row_newbcast:15 row_mask:0xf bank_mask:0xf
v_perm_b32 v24, v17, v17, v4
v_perm_b32 v25, v17, v17, v5
v_perm_b32 v26, v17, v17, v6
v_perm_b32 v27, v17, v17, v7
s_waitcnt vmcnt(17)
v_mfma_f32_16x16x32_bf16 v[84:87], v[184:187], v[20:23], v[84:87]
v_mov_b32_dpp v17, v77 row_newbcast:0 row_mask:0xf bank_mask:0xf
v_perm_b32 v20, v17, v17, v4
v_perm_b32 v21, v17, v17, v5
v_perm_b32 v22, v17, v17, v6
v_perm_b32 v23, v17, v17, v7
s_waitcnt vmcnt(16)
v_mfma_f32_16x16x32_bf16 v[84:87], v[188:191], v[24:27], v[84:87]
s_waitcnt vmcnt(8)
buffer_load_dwordx4 v[88:91], v16, s[56:59], s9 offen offset:0 nt
v_mov_b32_dpp v17, v77 row_newbcast:1 row_mask:0xf bank_mask:0xf
v_perm_b32 v24, v17, v17, v4
v_perm_b32 v25, v17, v17, v5
v_perm_b32 v26, v17, v17, v6
v_perm_b32 v27, v17, v17, v7
s_waitcnt vmcnt(16)
v_mfma_f32_16x16x32_bf16 v[84:87], v[192:195], v[20:23], v[84:87]
v_mov_b32_dpp v17, v77 row_newbcast:2 row_mask:0xf bank_mask:0xf
v_perm_b32 v20, v17, v17, v4
v_perm_b32 v21, v17, v17, v5
v_perm_b32 v22, v17, v17, v6
v_perm_b32 v23, v17, v17, v7
s_waitcnt vmcnt(15)
v_mfma_f32_16x16x32_bf16 v[84:87], v[196:199], v[24:27], v[84:87]
s_waitcnt vmcnt(8)
s_add_u32 s14, s9, 9216
buffer_load_dwordx4 v[92:95], v16, s[56:59], s14 offen offset:0 nt
v_mov_b32_dpp v17, v77 row_newbcast:3 row_mask:0xf bank_mask:0xf
v_perm_b32 v24, v17, v17, v4
v_perm_b32 v25, v17, v17, v5
v_perm_b32 v26, v17, v17, v6
v_perm_b32 v27, v17, v17, v7
s_waitcnt vmcnt(15)
v_mfma_f32_16x16x32_bf16 v[84:87], v[200:203], v[20:23], v[84:87]
v_mov_b32_dpp v17, v77 row_newbcast:4 row_mask:0xf bank_mask:0xf
v_perm_b32 v20, v17, v17, v4
v_perm_b32 v21, v17, v17, v5
v_perm_b32 v22, v17, v17, v6
v_perm_b32 v23, v17, v17, v7
s_waitcnt vmcnt(14)
v_mfma_f32_16x16x32_bf16 v[84:87], v[204:207], v[24:27], v[84:87]
s_waitcnt vmcnt(8)
s_add_u32 s14, s9, 18432
buffer_load_dwordx4 v[96:99], v16, s[56:59], s14 offen offset:0 nt
v_mov_b32_dpp v17, v77 row_newbcast:5 row_mask:0xf bank_mask:0xf
v_perm_b32 v24, v17, v17, v4
v_perm_b32 v25, v17, v17, v5
v_perm_b32 v26, v17, v17, v6
v_perm_b32 v27, v17, v17, v7
s_waitcnt vmcnt(14)
v_mfma_f32_16x16x32_bf16 v[84:87], v[208:211], v[20:23], v[84:87]
v_mov_b32_dpp v17, v77 row_newbcast:6 row_mask:0xf bank_mask:0xf
v_perm_b32 v20, v17, v17, v4
v_perm_b32 v21, v17, v17, v5
v_perm_b32 v22, v17, v17, v6
v_perm_b32 v23, v17, v17, v7
s_waitcnt vmcnt(13)
v_mfma_f32_16x16x32_bf16 v[84:87], v[212:215], v[24:27], v[84:87]
s_waitcnt vmcnt(8)
s_add_u32 s14, s9, 27648
buffer_load_dwordx4 v[100:103], v16, s[56:59], s14 offen offset:0 nt
v_mov_b32_dpp v17, v77 row_newbcast:7 row_mask:0xf bank_mask:0xf
v_perm_b32 v24, v17, v17, v4
v_perm_b32 v25, v17, v17, v5
v_perm_b32 v26, v17, v17, v6
v_perm_b32 v27, v17, v17, v7
s_waitcnt vmcnt(13)
v_mfma_f32_16x16x32_bf16 v[84:87], v[216:219], v[20:23], v[84:87]
v_mov_b32_dpp v17, v77 row_newbcast:8 row_mask:0xf bank_mask:0xf
v_perm_b32 v20, v17, v17, v4
v_perm_b32 v21, v17, v17, v5
v_perm_b32 v22, v17, v17, v6
v_perm_b32 v23, v17, v17, v7
s_waitcnt vmcnt(12)
v_mfma_f32_16x16x32_bf16 v[84:87], v[220:223], v[24:27], v[84:87]
s_waitcnt vmcnt(8)
buffer_load_dwordx4 v[104:107], v16, s[56:59], s9 offen offset:128 nt
v_mov_b32_dpp v17, v77 row_newbcast:9 row_mask:0xf bank_mask:0xf
v_perm_b32 v24, v17, v17, v4
v_perm_b32 v25, v17, v17, v5
v_perm_b32 v26, v17, v17, v6
v_perm_b32 v27, v17, v17, v7
s_waitcnt vmcnt(12)
v_mfma_f32_16x16x32_bf16 v[84:87], v[224:227], v[20:23], v[84:87]
v_mov_b32_dpp v17, v77 row_newbcast:10 row_mask:0xf bank_mask:0xf
v_perm_b32 v20, v17, v17, v4
v_perm_b32 v21, v17, v17, v5
v_perm_b32 v22, v17, v17, v6
v_perm_b32 v23, v17, v17, v7
s_waitcnt vmcnt(11)
v_mfma_f32_16x16x32_bf16 v[84:87], v[228:231], v[24:27], v[84:87]
s_waitcnt vmcnt(8)
s_add_u32 s14, s9, 9216
buffer_load_dwordx4 v[108:111], v16, s[56:59], s14 offen offset:128 nt
v_mov_b32_dpp v17, v77 row_newbcast:11 row_mask:0xf bank_mask:0xf
v_perm_b32 v24, v17, v17, v4
v_perm_b32 v25, v17, v17, v5
v_perm_b32 v26, v17, v17, v6
v_perm_b32 v27, v17, v17, v7
s_waitcnt vmcnt(11)
v_mfma_f32_16x16x32_bf16 v[84:87], v[232:235], v[20:23], v[84:87]
v_mov_b32_dpp v17, v77 row_newbcast:12 row_mask:0xf bank_mask:0xf
v_perm_b32 v20, v17, v17, v4
v_perm_b32 v21, v17, v17, v5
v_perm_b32 v22, v17, v17, v6
v_perm_b32 v23, v17, v17, v7
s_waitcnt vmcnt(10)
v_mfma_f32_16x16x32_bf16 v[84:87], v[236:239], v[24:27], v[84:87]
s_waitcnt vmcnt(8)
s_add_u32 s14, s9, 18432
buffer_load_dwordx4 v[112:115], v16, s[56:59], s14 offen offset:128 nt
v_mov_b32_dpp v17, v77 row_newbcast:13 row_mask:0xf bank_mask:0xf
v_perm_b32 v24, v17, v17, v4
v_perm_b32 v25, v17, v17, v5
v_perm_b32 v26, v17, v17, v6
v_perm_b32 v27, v17, v17, v7
s_waitcnt vmcnt(10)
v_mfma_f32_16x16x32_bf16 v[84:87], v[240:243], v[20:23], v[84:87]
s_waitcnt vmcnt(8)
s_add_u32 s14, s9, 27648
buffer_load_dwordx4 v[116:119], v16, s[56:59], s14 offen offset:128 nt
s_cmp_lg_u32 s3, 0
    s_cbranch_scc1 L_Bpv1
buffer_load_dwordx4 v[56:59], v16, s[56:59], s9 offen offset:1024 nt
s_add_u32 s14, s9, 9216
buffer_load_dwordx4 v[60:63], v16, s[56:59], s14 offen offset:1024 nt
s_add_u32 s14, s9, 18432
buffer_load_dwordx4 v[64:67], v16, s[56:59], s14 offen offset:1024 nt
s_add_u32 s14, s9, 27648
buffer_load_dwordx4 v[68:71], v16, s[56:59], s14 offen offset:1024 nt
v_mov_b32_dpp v17, v77 row_newbcast:14 row_mask:0xf bank_mask:0xf
v_perm_b32 v20, v17, v17, v4
v_perm_b32 v21, v17, v17, v5
v_perm_b32 v22, v17, v17, v6
v_perm_b32 v23, v17, v17, v7
s_waitcnt vmcnt(14)
v_mfma_f32_16x16x32_bf16 v[84:87], v[244:247], v[24:27], v[84:87]
v_mov_b32_dpp v17, v77 row_newbcast:15 row_mask:0xf bank_mask:0xf
v_perm_b32 v24, v17, v17, v4
v_perm_b32 v25, v17, v17, v5
v_perm_b32 v26, v17, v17, v6
v_perm_b32 v27, v17, v17, v7
s_waitcnt vmcnt(13)
v_mfma_f32_16x16x32_bf16 v[84:87], v[248:251], v[20:23], v[84:87]
s_waitcnt vmcnt(12)
v_mfma_f32_16x16x32_bf16 v[84:87], v[252:255], v[24:27], v[84:87]
s_branch L_Bpv2
L_Bpv1:
v_mov_b32_dpp v17, v77 row_newbcast:14 row_mask:0xf bank_mask:0xf
v_perm_b32 v20, v17, v17, v4
v_perm_b32 v21, v17, v17, v5
v_perm_b32 v22, v17, v17, v6
v_perm_b32 v23, v17, v17, v7
s_waitcnt vmcnt(10)
v_mfma_f32_16x16x32_bf16 v[84:87], v[244:247], v[24:27], v[84:87]
v_mov_b32_dpp v17, v77 row_newbcast:15 row_mask:0xf bank_mask:0xf
v_perm_b32 v24, v17, v17, v4
v_perm_b32 v25, v17, v17, v5
v_perm_b32 v26, v17, v17, v6
v_perm_b32 v27, v17, v17, v7
s_waitcnt vmcnt(9)
v_mfma_f32_16x16x32_bf16 v[84:87], v[248:251], v[20:23], v[84:87]
s_waitcnt vmcnt(8)
v_mfma_f32_16x16x32_bf16 v[84:87], v[252:255], v[24:27], v[84:87]
L_Bpv2:
    s_nop 6
    s_nop 0
ds_write_b128 v14, v[84:87]
    s_waitcnt lgkmcnt(0)
    s_barrier
    s_cmp_lg_u32 s3, 0
    s_cbranch_scc1 L_Btail
ds_read_b128 v[36:39], v15 offset:0
ds_read_b128 v[40:43], v15 offset:1024
ds_read_b128 v[44:47], v15 offset:2048
ds_read_b128 v[48:51], v15 offset:3072
s_waitcnt lgkmcnt(2)
v_add_f32 v36, v36, v40
v_add_f32 v37, v37, v41
v_add_f32 v38, v38, v42
v_add_f32 v39, v39, v43
s_waitcnt lgkmcnt(0)
v_add_f32 v44, v44, v48
v_add_f32 v45, v45, v49
v_add_f32 v46, v46, v50
v_add_f32 v47, v47, v51
v_add_f32 v36, v36, v44
v_add_f32 v37, v37, v45
v_add_f32 v38, v38, v46
v_add_f32 v39, v39, v47
v_cvt_pk_bf16_f32 v36, v36, v37
    v_cvt_pk_bf16_f32 v38, v38, v39
    v_mov_b32 v37, s4
    v_mov_b32 v39, s4
    buffer_store_dwordx4 v[36:39], v3, s[44:47], s70 offen offset:0 sc1
L_Btail:
s_waitcnt vmcnt(0)
s_mov_b32 s15, 200000
Lp_1:
buffer_load_dwordx4 v[36:39], v12, s[44:47], s5 offen sc1
buffer_load_dwordx4 v[52:55], v13, s[44:47], s5 offen sc1
s_waitcnt vmcnt(0)
v_max_u32 v72, v37, v39
v_min_u32 v73, v37, v39
v_max3_u32 v72, v72, v53, v55
v_min3_u32 v73, v73, v53, v55
v_cmp_eq_u32 s[12:13], s4, v72
v_cmp_eq_u32 vcc, s4, v73
    s_nop 0
s_and_b64 vcc, vcc, s[12:13]
s_andn2_b64 exec, exec, vcc
    s_cbranch_execz Ld_2
s_sleep 4
s_sub_u32 s15, s15, 1
    s_cmp_lg_u32 s15, 0
    s_cbranch_scc1 Lp_1
Ld_2:
s_mov_b64 exec, -1
v_mov_b32 v72, v52
    v_and_b32 v37, 0xffff0000, v36
    v_lshlrev_b32 v36, 16, v36
    v_max_f32_dpp v72, v72, v72 quad_perm:[1,0,3,2] row_mask:0xf bank_mask:0xf
    v_and_b32 v39, 0xffff0000, v38
    v_lshlrev_b32 v38, 16, v38
    v_max_f32_dpp v72, v72, v72 quad_perm:[2,3,0,1] row_mask:0xf bank_mask:0xf
    s_nop 1
    v_max_f32_dpp v72, v72, v72 row_half_mirror row_mask:0xf bank_mask:0xf
    v_sub_f32 v72, v52, v72
    v_exp_f32 v72, v72
    s_nop 0
    v_mul_f32 v54, v54, v72
v_mul_f32 v36, v36, v72
v_mul_f32 v37, v37, v72
v_mul_f32 v38, v38, v72
v_mul_f32 v39, v39, v72
v_add_f32_dpp v54, v54, v54 quad_perm:[1,0,3,2] row_mask:0xf bank_mask:0xf
v_add_f32_dpp v36, v36, v36 quad_perm:[1,0,3,2] row_mask:0xf bank_mask:0xf
v_add_f32_dpp v37, v37, v37 quad_perm:[1,0,3,2] row_mask:0xf bank_mask:0xf
v_add_f32_dpp v38, v38, v38 quad_perm:[1,0,3,2] row_mask:0xf bank_mask:0xf
v_add_f32_dpp v39, v39, v39 quad_perm:[1,0,3,2] row_mask:0xf bank_mask:0xf
v_add_f32_dpp v54, v54, v54 quad_perm:[2,3,0,1] row_mask:0xf bank_mask:0xf
v_add_f32_dpp v36, v36, v36 quad_perm:[2,3,0,1] row_mask:0xf bank_mask:0xf
v_add_f32_dpp v37, v37, v37 quad_perm:[2,3,0,1] row_mask:0xf bank_mask:0xf
v_add_f32_dpp v38, v38, v38 quad_perm:[2,3,0,1] row_mask:0xf bank_mask:0xf
v_add_f32_dpp v39, v39, v39 quad_perm:[2,3,0,1] row_mask:0xf bank_mask:0xf
v_add_f32_dpp v54, v54, v54 row_half_mirror row_mask:0xf bank_mask:0xf
v_add_f32_dpp v36, v36, v36 row_half_mirror row_mask:0xf bank_mask:0xf
v_add_f32_dpp v37, v37, v37 row_half_mirror row_mask:0xf bank_mask:0xf
v_add_f32_dpp v38, v38, v38 row_half_mirror row_mask:0xf bank_mask:0xf
v_add_f32_dpp v39, v39, v39 row_half_mirror row_mask:0xf bank_mask:0xf
v_rcp_f32 v54, v54
    s_nop 0
v_mul_f32 v36, v36, v54
v_mul_f32 v37, v37, v54
v_mul_f32 v38, v38, v54
v_mul_f32 v39, v39, v54
v_cvt_pk_bf16_f32 v36, v36, v37
    v_cvt_pk_bf16_f32 v37, v38, v39
v_perm_b32 v20, v36, v36, v8
v_perm_b32 v21, v36, v36, v9
v_perm_b32 v22, v36, v36, v10
v_perm_b32 v23, v36, v36, v11
v_perm_b32 v24, v36, v36, v120
v_perm_b32 v25, v36, v36, v121
v_perm_b32 v26, v36, v36, v122
v_perm_b32 v27, v36, v36, v123
v_mfma_f32_16x16x32_bf16 v[128:131], v[88:91], v[20:23], 0
v_mfma_f32_16x16x32_bf16 v[132:135], v[104:107], v[20:23], 0
v_perm_b32 v28, v37, v37, v8
v_perm_b32 v29, v37, v37, v9
v_perm_b32 v30, v37, v37, v10
v_perm_b32 v31, v37, v37, v11
v_mfma_f32_16x16x32_bf16 v[128:131], v[92:95], v[24:27], v[128:131]
v_mfma_f32_16x16x32_bf16 v[132:135], v[108:111], v[24:27], v[132:135]
v_perm_b32 v32, v37, v37, v120
v_perm_b32 v33, v37, v37, v121
v_perm_b32 v34, v37, v37, v122
v_perm_b32 v35, v37, v37, v123
v_mfma_f32_16x16x32_bf16 v[128:131], v[96:99], v[28:31], v[128:131]
v_mfma_f32_16x16x32_bf16 v[132:135], v[112:115], v[28:31], v[132:135]
v_mov_b32 v141, s4
    v_mov_b32 v143, s4
v_mfma_f32_16x16x32_bf16 v[128:131], v[100:103], v[32:35], v[128:131]
v_mfma_f32_16x16x32_bf16 v[132:135], v[116:119], v[32:35], v[132:135]
s_cmp_lg_u32 s3, 0
    s_cbranch_scc1 L_o1B
v_mfma_f32_16x16x32_bf16 v[136:139], v[56:59], v[20:23], 0
v_mfma_f32_16x16x32_bf16 v[136:139], v[60:63], v[24:27], v[136:139]
v_mfma_f32_16x16x32_bf16 v[136:139], v[64:67], v[28:31], v[136:139]
v_mfma_f32_16x16x32_bf16 v[136:139], v[68:71], v[32:35], v[136:139]
L_o1B:
s_nop 5
v_permlane32_swap_b32 v128, v132
v_permlane32_swap_b32 v129, v133
v_permlane32_swap_b32 v130, v134
v_permlane32_swap_b32 v131, v135
v_add_f32_dpp v128, v132, v128 row_ror:8 row_mask:0xf bank_mask:0xf
v_add_f32_dpp v129, v133, v129 row_ror:8 row_mask:0xf bank_mask:0xf
v_add_f32_dpp v130, v134, v130 row_ror:8 row_mask:0xf bank_mask:0xf
v_add_f32_dpp v131, v135, v131 row_ror:8 row_mask:0xf bank_mask:0xf
v_cvt_pk_bf16_f32 v140, v128, v129
    v_cvt_pk_bf16_f32 v142, v130, v131
s_mov_b32 exec_lo, 0x00ff00ff
    s_mov_b32 exec_hi, 0x00ff00ff
    buffer_store_dwordx4 v[140:143], v124, s[44:47], s71 offen sc1
    s_mov_b64 exec, -1
    s_cbranch_scc1 L_o2B
v_permlane32_swap_b32 v136, v132
v_permlane32_swap_b32 v137, v133
v_permlane32_swap_b32 v138, v134
v_permlane32_swap_b32 v139, v135
v_add_f32_dpp v136, v132, v136 row_ror:8 row_mask:0xf bank_mask:0xf
v_add_f32_dpp v137, v133, v137 row_ror:8 row_mask:0xf bank_mask:0xf
v_add_f32_dpp v138, v134, v138 row_ror:8 row_mask:0xf bank_mask:0xf
v_add_f32_dpp v139, v135, v139 row_ror:8 row_mask:0xf bank_mask:0xf
v_cvt_pk_bf16_f32 v140, v136, v137
    v_cvt_pk_bf16_f32 v142, v138, v139
s_mov_b32 exec_lo, 0x00ff00ff
    s_mov_b32 exec_hi, 0
    buffer_store_dwordx4 v[140:143], v124, s[44:47], s71 offen offset:2048 sc1
    s_mov_b64 exec, -1
L_o2B:
s_endpgm
L_A:
s_mov_b32 s48, s20
    s_and_b32 s49, s21, 0xffff
    s_mov_b32 s50, 4718592
    s_mov_b32 s51, 0x20000
s_and_b32 s7, s0, 3
    s_mul_i32 s8, s7, 144
    s_mul_i32 s9, s3, 36
    s_add_u32 s8, s8, s9
    s_lshl_b32 s9, s8, 1
    s_add_u32 s10, s16, s9
    s_addc_u32 s11, s17, 0
    s_lshl_b32 s8, s8, 13
    s_lshr_b32 s9, s0, 2
    s_lshl_b32 s9, s9, 8
    s_add_u32 s8, s8, s9
    v_lshlrev_b32 v16, 4, v2
    v_lshl_add_u32 v16, v1, 13, v16
s_load_dwordx16 s[64:79], s[10:11], 0
    s_load_dwordx2 s[80:81], s[10:11], 64
buffer_load_dwordx4 v[64:67], v16, s[48:51], s8 offen nt
s_add_u32 s8, s8, 32768
buffer_load_dwordx4 v[68:71], v16, s[48:51], s8 offen nt
s_add_u32 s8, s8, 32768
buffer_load_dwordx4 v[72:75], v16, s[48:51], s8 offen nt
s_add_u32 s8, s8, 32768
buffer_load_dwordx4 v[76:79], v16, s[48:51], s8 offen nt
s_add_u32 s8, s8, 32768
buffer_load_dwordx4 v[80:83], v16, s[48:51], s8 offen nt
s_add_u32 s8, s8, 32768
buffer_load_dwordx4 v[84:87], v16, s[48:51], s8 offen nt
s_add_u32 s8, s8, 32768
buffer_load_dwordx4 v[88:91], v16, s[48:51], s8 offen nt
s_add_u32 s8, s8, 32768
buffer_load_dwordx4 v[92:95], v16, s[48:51], s8 offen nt
s_add_u32 s8, s8, 32768
buffer_load_dwordx4 v[96:99], v16, s[48:51], s8 offen nt
s_barrier
s_mov_b32 s48, s18
    s_and_b32 s49, s19, 0xffff
    s_mov_b32 s50, 16777216
    s_mov_b32 s51, 0x20000
s_mov_b32 s52, s24
    s_and_b32 s53, s25, 0xffff
    s_mov_b32 s54, 4194304
    s_mov_b32 s55, 0x20000
s_mov_b32 s56, s26
    s_and_b32 s57, s27, 0xffff
    s_mov_b32 s58, 4718592
    s_mov_b32 s59, 0x20000
s_mov_b32 s6, s2
    s_xor_b32 s8, s6, 0
    s_lshl_b32 s8, s8, 15
    s_lshl_b32 s9, s3, 13
    s_add_u32 s8, s8, s9
    s_lshl_b32 s9, s3, 15
    s_mul_i32 s7, s2, 5
    s_mul_i32 s10, s3, 9
    s_add_u32 s7, s7, s10
    s_lshl_b32 s7, s7, 10
v_lshlrev_b32 v17, 1, v1
v_add_u32 v16, 1, v17
    v_lshl_or_b32 v16, v16, 8, v17
    v_and_b32 v18, 1, v0
    v_lshlrev_b32 v18, 4, v18
    v_xor_b32 v16, 0x0c0c, v16
    v_lshlrev_b32 v16, v18, v16
    v_xor_b32 v16, 0x0c0c0c0c, v16
    v_bfe_u32 v18, v0, 1, 2
v_cmp_eq_u32 vcc, 0, v18
    v_mov_b32 v196, 0x0c0c0c0c
    s_nop 0
    v_cndmask_b32 v196, v196, v16, vcc
v_cmp_eq_u32 vcc, 1, v18
    v_mov_b32 v197, 0x0c0c0c0c
    s_nop 0
    v_cndmask_b32 v197, v197, v16, vcc
v_cmp_eq_u32 vcc, 2, v18
    v_mov_b32 v198, 0x0c0c0c0c
    s_nop 0
    v_cndmask_b32 v198, v198, v16, vcc
v_cmp_eq_u32 vcc, 3, v18
    v_mov_b32 v199, 0x0c0c0c0c
    s_nop 0
    v_cndmask_b32 v199, v199, v16, vcc
s_waitcnt lgkmcnt(0)
    s_add_u32 s4, s4, 1
v_mov_b32 v16, s64
v_perm_b32 v100, s65, v16, v196
v_perm_b32 v101, s65, v16, v197
v_perm_b32 v102, s65, v16, v198
v_perm_b32 v103, s65, v16, v199
v_mov_b32 v16, s66
v_perm_b32 v104, s67, v16, v196
v_perm_b32 v105, s67, v16, v197
v_perm_b32 v106, s67, v16, v198
v_perm_b32 v107, s67, v16, v199
v_mov_b32 v16, s68
v_perm_b32 v108, s69, v16, v196
v_perm_b32 v109, s69, v16, v197
v_perm_b32 v110, s69, v16, v198
v_perm_b32 v111, s69, v16, v199
v_mov_b32 v16, s70
v_perm_b32 v112, s71, v16, v196
v_perm_b32 v113, s71, v16, v197
v_perm_b32 v114, s71, v16, v198
v_perm_b32 v115, s71, v16, v199
v_mov_b32 v16, s72
v_perm_b32 v116, s73, v16, v196
v_perm_b32 v117, s73, v16, v197
v_perm_b32 v118, s73, v16, v198
v_perm_b32 v119, s73, v16, v199
v_mov_b32 v16, s74
v_perm_b32 v120, s75, v16, v196
v_perm_b32 v121, s75, v16, v197
v_perm_b32 v122, s75, v16, v198
v_perm_b32 v123, s75, v16, v199
v_mov_b32 v16, s76
v_perm_b32 v124, s77, v16, v196
v_perm_b32 v125, s77, v16, v197
v_perm_b32 v126, s77, v16, v198
v_perm_b32 v127, s77, v16, v199
v_mov_b32 v16, s78
v_perm_b32 v128, s79, v16, v196
v_perm_b32 v129, s79, v16, v197
v_perm_b32 v130, s79, v16, v198
v_perm_b32 v131, s79, v16, v199
v_mov_b32 v16, s80
v_perm_b32 v132, s81, v16, v196
v_perm_b32 v133, s81, v16, v197
v_perm_b32 v134, s81, v16, v198
v_perm_b32 v135, s81, v16, v199
s_waitcnt vmcnt(8)
v_mfma_f32_16x16x32_bf16 v[44:47], v[64:67], v[100:103], 0
s_waitcnt vmcnt(7)
v_mfma_f32_16x16x32_bf16 v[44:47], v[68:71], v[104:107], v[44:47]
s_waitcnt vmcnt(6)
v_mfma_f32_16x16x32_bf16 v[44:47], v[72:75], v[108:111], v[44:47]
s_waitcnt vmcnt(5)
v_mfma_f32_16x16x32_bf16 v[44:47], v[76:79], v[112:115], v[44:47]
s_waitcnt vmcnt(4)
v_mfma_f32_16x16x32_bf16 v[44:47], v[80:83], v[116:119], v[44:47]
s_waitcnt vmcnt(3)
v_mfma_f32_16x16x32_bf16 v[44:47], v[84:87], v[120:123], v[44:47]
s_waitcnt vmcnt(2)
v_mfma_f32_16x16x32_bf16 v[44:47], v[88:91], v[124:127], v[44:47]
s_waitcnt vmcnt(1)
v_mfma_f32_16x16x32_bf16 v[44:47], v[92:95], v[128:131], v[44:47]
s_waitcnt vmcnt(0)
v_mfma_f32_16x16x32_bf16 v[44:47], v[96:99], v[132:135], v[44:47]
v_lshl_add_u32 v16, s3, 15, v3
    v_add_u32 v16, 31744, v16
    s_nop 5
    ds_write_b128 v16, v[44:47]
    s_waitcnt lgkmcnt(0)
    s_barrier
s_barrier
v_xor_b32 v15, 0, v3
s_add_u32 m0, s9, 0
s_and_b32 s14, s7, 7168
s_add_u32 s14, s14, s8
s_add_u32 s7, s7, 1024
buffer_load_dwordx4 v15, s[48:51], s14 offen nt lds
v_xor_b32 v15, 64, v3
s_add_u32 m0, s9, 1024
s_and_b32 s14, s7, 7168
s_add_u32 s14, s14, s8
s_add_u32 s7, s7, 1024
s_waitcnt vmcnt(9)
buffer_load_dwordx4 v15, s[48:51], s14 offen nt lds
v_xor_b32 v15, 128, v3
s_add_u32 m0, s9, 2048
s_and_b32 s14, s7, 7168
s_add_u32 s14, s14, s8
s_add_u32 s7, s7, 1024
s_waitcnt vmcnt(9)
buffer_load_dwordx4 v15, s[48:51], s14 offen nt lds
v_xor_b32 v15, 192, v3
s_add_u32 m0, s9, 3072
s_and_b32 s14, s7, 7168
s_add_u32 s14, s14, s8
s_add_u32 s7, s7, 1024
s_waitcnt vmcnt(9)
buffer_load_dwordx4 v15, s[48:51], s14 offen nt lds
v_xor_b32 v15, 16, v3
s_add_u32 m0, s9, 4096
s_and_b32 s14, s7, 7168
s_add_u32 s14, s14, s8
s_add_u32 s7, s7, 1024
s_waitcnt vmcnt(9)
buffer_load_dwordx4 v15, s[48:51], s14 offen nt lds
v_xor_b32 v15, 80, v3
s_add_u32 m0, s9, 5120
s_and_b32 s14, s7, 7168
s_add_u32 s14, s14, s8
s_add_u32 s7, s7, 1024
s_waitcnt vmcnt(9)
buffer_load_dwordx4 v15, s[48:51], s14 offen nt lds
v_xor_b32 v15, 144, v3
s_add_u32 m0, s9, 6144
s_and_b32 s14, s7, 7168
s_add_u32 s14, s14, s8
s_add_u32 s7, s7, 1024
s_waitcnt vmcnt(9)
buffer_load_dwordx4 v15, s[48:51], s14 offen nt lds
v_and_b32 v16, 3, v0
    v_lshlrev_b32 v16, 2, v16
    v_bfe_u32 v17, v0, 2, 2
    v_or_b32 v16, v16, v17
    v_lshlrev_b32 v16, 4, v16
    v_lshrrev_b32 v17, 5, v0
    v_lshl_add_u32 v16, v17, 9, v16
    v_and_b32 v18, 31, v0
    v_lshl_add_u32 v16, v18, 10, v16
    v_add_u32 v28, s9, v16
    v_lshlrev_b32 v16, 4, v18
    v_lshl_add_u32 v16, v17, 14, v16
    v_add_u32 v20, 131072, v16
v_xor_b32 v15, 208, v3
s_add_u32 m0, s9, 7168
s_and_b32 s14, s7, 7168
s_add_u32 s14, s14, s8
s_add_u32 s7, s7, 1024
s_waitcnt vmcnt(9)
buffer_load_dwordx4 v15, s[48:51], s14 offen nt lds
v_xor_b32 v29, 16, v28
v_xor_b32 v30, 32, v28
v_xor_b32 v31, 48, v28
v_xor_b32 v32, 64, v28
v_xor_b32 v33, 80, v28
v_xor_b32 v34, 96, v28
v_xor_b32 v35, 112, v28
v_xor_b32 v36, 128, v28
v_xor_b32 v37, 144, v28
v_xor_b32 v38, 160, v28
v_xor_b32 v39, 176, v28
v_xor_b32 v40, 192, v28
v_xor_b32 v41, 208, v28
v_xor_b32 v42, 224, v28
v_xor_b32 v43, 240, v28
v_xor_b32 v15, 32, v3
s_add_u32 m0, s9, 8192
s_and_b32 s14, s7, 7168
s_add_u32 s14, s14, s8
s_add_u32 s14, s14, 4194304
s_add_u32 s7, s7, 1024
s_waitcnt vmcnt(9)
buffer_load_dwordx4 v15, s[48:51], s14 offen nt lds
v_xor_b32 v21, 16, v20
v_xor_b32 v22, 32, v20
v_xor_b32 v23, 48, v20
v_xor_b32 v24, 64, v20
v_xor_b32 v25, 80, v20
v_xor_b32 v26, 96, v20
v_xor_b32 v27, 112, v20
v_xor_b32 v15, 96, v3
s_add_u32 m0, s9, 9216
s_and_b32 s14, s7, 7168
s_add_u32 s14, s14, s8
s_add_u32 s14, s14, 4194304
s_add_u32 s7, s7, 1024
s_waitcnt vmcnt(9)
buffer_load_dwordx4 v15, s[48:51], s14 offen nt lds
v_lshrrev_b32 v16, 5, v0
    v_bfe_u32 v17, v0, 2, 2
    v_lshl_add_u32 v18, v17, 2, v16
    v_lshl_add_u32 v16, v16, 2, v17
    v_bfe_u32 v17, v0, 4, 1
    v_bfe_u32 v19, v0, 1, 1
    v_lshl_add_u32 v17, v17, 1, v19
    v_xor_b32 v17, v17, v18
    v_lshlrev_b32 v17, 4, v17
    v_lshl_add_u32 v16, v16, 10, v17
    v_and_b32 v17, 1, v0
    v_lshl_add_u32 v16, v17, 3, v16
    v_lshl_add_u32 v16, s3, 8, v16
v_xor_b32 v4, 0, v16
v_xor_b32 v5, 32, v16
v_xor_b32 v6, 64, v16
v_xor_b32 v7, 96, v16
v_xor_b32 v8, 128, v16
v_xor_b32 v9, 160, v16
v_xor_b32 v10, 192, v16
v_xor_b32 v11, 224, v16
v_xor_b32 v15, 160, v3
s_add_u32 m0, s9, 10240
s_and_b32 s14, s7, 7168
s_add_u32 s14, s14, s8
s_add_u32 s14, s14, 4194304
s_add_u32 s7, s7, 1024
s_waitcnt vmcnt(9)
buffer_load_dwordx4 v15, s[48:51], s14 offen nt lds
v_add_u32 v12, 135168, v3
    v_lshlrev_b32 v14, 4, v2
    v_lshl_add_u32 v14, v1, 14, v14
v_xor_b32 v15, 224, v3
s_add_u32 m0, s9, 11264
s_and_b32 s14, s7, 7168
s_add_u32 s14, s14, s8
s_add_u32 s14, s14, 4194304
s_add_u32 s7, s7, 1024
s_waitcnt vmcnt(9)
buffer_load_dwordx4 v15, s[48:51], s14 offen nt lds
v_lshrrev_b32 v60, 3, v0
    v_mul_u32_u24 v60, 1152, v60
    v_and_b32 v16, 7, v0
    v_lshl_add_u32 v60, v16, 4, v60
    s_lshl_b32 s5, s3, 12
    v_lshlrev_b32 v16, 7, v0
    v_add_u32 v16, s5, v16
    s_lshl_b32 s5, s1, 7
    v_mov_b32 v17, s5
    v_cmp_gt_u32 vcc, 32, v0
    s_nop 1
    v_cndmask_b32 v61, v17, v16, vcc
    v_lshrrev_b32 v16, 3, v0
    v_lshl_add_u32 v16, s3, 3, v16
    v_and_b32 v17, 7, v0
    v_lshlrev_b32 v62, 4, v17
    v_lshl_add_u32 v62, v16, 10, v62
    v_xor_b32 v16, v16, v17
    v_lshlrev_b32 v16, 4, v16
    v_lshl_add_u32 v16, v17, 9, v16
    v_add_u32 v63, 131072, v16
    s_mov_b32 s5, 16384
v_xor_b32 v15, 48, v3
s_add_u32 m0, s9, 12288
s_and_b32 s14, s7, 7168
s_add_u32 s14, s14, s8
s_add_u32 s14, s14, 4194304
s_add_u32 s7, s7, 1024
s_waitcnt vmcnt(9)
buffer_load_dwordx4 v15, s[48:51], s14 offen nt lds
v_bfe_u32 v17, v0, 3, 1
    v_lshlrev_b32 v17, 1, v17
v_add_u32 v16, 1, v17
    v_lshl_or_b32 v16, v16, 8, v17
    v_and_b32 v18, 1, v0
    v_lshlrev_b32 v18, 4, v18
    v_xor_b32 v16, 0x0c0c, v16
    v_lshlrev_b32 v16, v18, v16
    v_xor_b32 v16, 0x0c0c0c0c, v16
    v_bfe_u32 v18, v0, 1, 2
v_cmp_eq_u32 vcc, 0, v18
    v_mov_b32 v244, 0x0c0c0c0c
    s_nop 0
    v_cndmask_b32 v244, v244, v16, vcc
v_cmp_eq_u32 vcc, 1, v18
    v_mov_b32 v245, 0x0c0c0c0c
    s_nop 0
    v_cndmask_b32 v245, v245, v16, vcc
v_cmp_eq_u32 vcc, 2, v18
    v_mov_b32 v246, 0x0c0c0c0c
    s_nop 0
    v_cndmask_b32 v246, v246, v16, vcc
v_cmp_eq_u32 vcc, 3, v18
    v_mov_b32 v247, 0x0c0c0c0c
    s_nop 0
    v_cndmask_b32 v247, v247, v16, vcc
v_mov_b32 v17, 0
v_add_u32 v16, 1, v17
    v_lshl_or_b32 v16, v16, 8, v17
    v_and_b32 v18, 1, v0
    v_lshlrev_b32 v18, 4, v18
    v_xor_b32 v16, 0x0c0c, v16
    v_lshlrev_b32 v16, v18, v16
    v_xor_b32 v16, 0x0c0c0c0c, v16
    v_bfe_u32 v18, v0, 1, 2
v_cmp_eq_u32 vcc, 0, v18
    v_mov_b32 v248, 0x0c0c0c0c
    s_nop 0
    v_cndmask_b32 v248, v248, v16, vcc
v_cmp_eq_u32 vcc, 1, v18
    v_mov_b32 v249, 0x0c0c0c0c
    s_nop 0
    v_cndmask_b32 v249, v249, v16, vcc
v_cmp_eq_u32 vcc, 2, v18
    v_mov_b32 v250, 0x0c0c0c0c
    s_nop 0
    v_cndmask_b32 v250, v250, v16, vcc
v_cmp_eq_u32 vcc, 3, v18
    v_mov_b32 v251, 0x0c0c0c0c
    s_nop 0
    v_cndmask_b32 v251, v251, v16, vcc
v_mov_b32 v17, 2
v_add_u32 v16, 1, v17
    v_lshl_or_b32 v16, v16, 8, v17
    v_and_b32 v18, 1, v0
    v_lshlrev_b32 v18, 4, v18
    v_xor_b32 v16, 0x0c0c, v16
    v_lshlrev_b32 v16, v18, v16
    v_xor_b32 v16, 0x0c0c0c0c, v16
    v_bfe_u32 v18, v0, 1, 2
v_cmp_eq_u32 vcc, 0, v18
    v_mov_b32 v252, 0x0c0c0c0c
    s_nop 0
    v_cndmask_b32 v252, v252, v16, vcc
v_cmp_eq_u32 vcc, 1, v18
    v_mov_b32 v253, 0x0c0c0c0c
    s_nop 0
    v_cndmask_b32 v253, v253, v16, vcc
v_cmp_eq_u32 vcc, 2, v18
    v_mov_b32 v254, 0x0c0c0c0c
    s_nop 0
    v_cndmask_b32 v254, v254, v16, vcc
v_cmp_eq_u32 vcc, 3, v18
    v_mov_b32 v255, 0x0c0c0c0c
    s_nop 0
    v_cndmask_b32 v255, v255, v16, vcc
s_mov_b32 s13, 65536
    s_mov_b32 s12, 32768
v_xor_b32 v15, 112, v3
s_add_u32 m0, s9, 13312
s_and_b32 s14, s7, 7168
s_add_u32 s14, s14, s8
s_add_u32 s14, s14, 4194304
s_add_u32 s7, s7, 1024
s_waitcnt vmcnt(9)
buffer_load_dwordx4 v15, s[48:51], s14 offen nt lds
v_xor_b32 v15, 176, v3
s_add_u32 m0, s9, 14336
s_and_b32 s14, s7, 7168
s_add_u32 s14, s14, s8
s_add_u32 s14, s14, 4194304
s_add_u32 s7, s7, 1024
s_waitcnt vmcnt(9)
buffer_load_dwordx4 v15, s[48:51], s14 offen nt lds
v_xor_b32 v15, 240, v3
s_add_u32 m0, s9, 15360
s_and_b32 s14, s7, 7168
s_add_u32 s14, s14, s8
s_add_u32 s14, s14, 4194304
s_add_u32 s7, s7, 1024
s_waitcnt vmcnt(9)
buffer_load_dwordx4 v15, s[48:51], s14 offen nt lds
v_xor_b32 v15, 0, v3
s_add_u32 m0, s9, 16384
s_and_b32 s14, s7, 7168
s_add_u32 s14, s14, s8
s_add_u32 s14, s14, 8388608
s_add_u32 s7, s7, 1024
s_waitcnt vmcnt(9)
buffer_load_dwordx4 v15, s[48:51], s14 offen nt lds
v_xor_b32 v15, 64, v3
s_add_u32 m0, s9, 17408
s_and_b32 s14, s7, 7168
s_add_u32 s14, s14, s8
s_add_u32 s14, s14, 8388608
s_add_u32 s7, s7, 1024
s_waitcnt vmcnt(9)
buffer_load_dwordx4 v15, s[48:51], s14 offen nt lds
v_xor_b32 v15, 128, v3
s_add_u32 m0, s9, 18432
s_and_b32 s14, s7, 7168
s_add_u32 s14, s14, s8
s_add_u32 s14, s14, 8388608
s_add_u32 s7, s7, 1024
s_waitcnt vmcnt(9)
buffer_load_dwordx4 v15, s[48:51], s14 offen nt lds
v_xor_b32 v15, 192, v3
s_add_u32 m0, s9, 19456
s_and_b32 s14, s7, 7168
s_add_u32 s14, s14, s8
s_add_u32 s14, s14, 8388608
s_add_u32 s7, s7, 1024
s_waitcnt vmcnt(9)
buffer_load_dwordx4 v15, s[48:51], s14 offen nt lds
v_xor_b32 v15, 16, v3
s_add_u32 m0, s9, 20480
s_and_b32 s14, s7, 7168
s_add_u32 s14, s14, s8
s_add_u32 s14, s14, 8388608
s_add_u32 s7, s7, 1024
s_waitcnt vmcnt(9)
buffer_load_dwordx4 v15, s[48:51], s14 offen nt lds
buffer_load_dword v229, v61, s[44:47], s12 offen sc1
v_xor_b32 v15, 80, v3
s_add_u32 m0, s9, 21504
s_and_b32 s14, s7, 7168
s_add_u32 s14, s14, s8
s_add_u32 s14, s14, 8388608
s_add_u32 s7, s7, 1024
s_waitcnt vmcnt(9)
buffer_load_dwordx4 v15, s[48:51], s14 offen nt lds
v_xor_b32 v15, 144, v3
s_add_u32 m0, s9, 22528
s_and_b32 s14, s7, 7168
s_add_u32 s14, s14, s8
s_add_u32 s14, s14, 8388608
s_add_u32 s7, s7, 1024
s_waitcnt vmcnt(9)
buffer_load_dwordx4 v15, s[48:51], s14 offen nt lds
v_xor_b32 v15, 208, v3
s_add_u32 m0, s9, 23552
s_and_b32 s14, s7, 7168
s_add_u32 s14, s14, s8
s_add_u32 s14, s14, 8388608
s_add_u32 s7, s7, 1024
s_waitcnt vmcnt(9)
buffer_load_dwordx4 v15, s[48:51], s14 offen nt lds
v_xor_b32 v15, 32, v3
s_add_u32 m0, s9, 24576
s_and_b32 s14, s7, 7168
s_add_u32 s14, s14, s8
s_add_u32 s14, s14, 12582912
s_add_u32 s7, s7, 1024
s_waitcnt vmcnt(9)
buffer_load_dwordx4 v15, s[48:51], s14 offen nt lds
v_xor_b32 v15, 96, v3
s_add_u32 m0, s9, 25600
s_and_b32 s14, s7, 7168
s_add_u32 s14, s14, s8
s_add_u32 s14, s14, 12582912
s_add_u32 s7, s7, 1024
s_waitcnt vmcnt(9)
buffer_load_dwordx4 v15, s[48:51], s14 offen nt lds
v_xor_b32 v15, 160, v3
s_add_u32 m0, s9, 26624
s_and_b32 s14, s7, 7168
s_add_u32 s14, s14, s8
s_add_u32 s14, s14, 12582912
s_add_u32 s7, s7, 1024
s_waitcnt vmcnt(9)
buffer_load_dwordx4 v15, s[48:51], s14 offen nt lds
v_xor_b32 v15, 224, v3
s_add_u32 m0, s9, 27648
s_and_b32 s14, s7, 7168
s_add_u32 s14, s14, s8
s_add_u32 s14, s14, 12582912
s_add_u32 s7, s7, 1024
s_waitcnt vmcnt(9)
buffer_load_dwordx4 v15, s[48:51], s14 offen nt lds
v_xor_b32 v15, 48, v3
s_add_u32 m0, s9, 28672
s_and_b32 s14, s7, 7168
s_add_u32 s14, s14, s8
s_add_u32 s14, s14, 12582912
s_add_u32 s7, s7, 1024
s_waitcnt vmcnt(9)
buffer_load_dwordx4 v15, s[48:51], s14 offen nt lds
v_xor_b32 v15, 112, v3
s_add_u32 m0, s9, 29696
s_and_b32 s14, s7, 7168
s_add_u32 s14, s14, s8
s_add_u32 s14, s14, 12582912
s_add_u32 s7, s7, 1024
s_waitcnt vmcnt(9)
buffer_load_dwordx4 v15, s[48:51], s14 offen nt lds
v_xor_b32 v15, 176, v3
s_add_u32 m0, s9, 30720
s_and_b32 s14, s7, 7168
s_add_u32 s14, s14, s8
s_add_u32 s14, s14, 12582912
s_add_u32 s7, s7, 1024
s_waitcnt vmcnt(9)
buffer_load_dwordx4 v15, s[48:51], s14 offen nt lds
v_xor_b32 v15, 240, v3
s_add_u32 m0, s9, 31744
s_and_b32 s14, s7, 7168
s_add_u32 s14, s14, s8
s_add_u32 s14, s14, 12582912
s_add_u32 s7, s7, 1024
s_waitcnt vmcnt(9)
buffer_load_dwordx4 v15, s[48:51], s14 offen nt lds
s_and_b32 s10, s0, 3
    s_lshl_b32 s10, s10, 7
    s_lshr_b32 s8, s3, 1
    s_lshl_b32 s8, s8, 6
    s_add_u32 s10, s10, s8
    s_and_b32 s8, s3, 1
    s_lshl_b32 s8, s8, 3
    s_add_u32 s10, s10, s8
    s_lshl_b32 s10, s10, 13
    s_mov_b32 s1, s0
    s_lshr_b32 s8, s1, 2
    s_lshl_b32 s8, s8, 8
    s_add_u32 s7, s10, s8
    s_mul_i32 s8, s1, 36864
    s_lshl_b32 s10, s3, 8
    s_add_u32 s8, s8, s10
    v_mov_b32 v15, v60
s_waitcnt vmcnt(11)
v_cmp_eq_u32 vcc, s4, v229
    s_nop 0
    s_cmp_eq_u64 vcc, exec
    s_cbranch_scc0 L_Anospec
    s_waitcnt vmcnt(3)
    s_mov_b32 exec_lo, 0
    buffer_load_dword v228, v61, s[44:47], s5 offen sc1
    s_mov_b32 exec_lo, -1
buffer_load_dwordx4 v[196:199], v62, s[44:47], s13 offen offset:0 sc1
buffer_load_dwordx4 v[200:203], v62, s[44:47], s13 offen offset:128 sc1
buffer_load_dwordx4 v[204:207], v62, s[44:47], s13 offen offset:256 sc1
buffer_load_dwordx4 v[208:211], v62, s[44:47], s13 offen offset:384 sc1
buffer_load_dwordx4 v[212:215], v62, s[44:47], s13 offen offset:512 sc1
buffer_load_dwordx4 v[216:219], v62, s[44:47], s13 offen offset:640 sc1
buffer_load_dwordx4 v[220:223], v62, s[44:47], s13 offen offset:768 sc1
buffer_load_dwordx4 v[224:227], v62, s[44:47], s13 offen offset:896 sc1
s_waitcnt vmcnt(0)
    v_cmp_eq_u32 s[74:75], s4, v228
    s_nop 0
    s_cmp_eq_u32 s75, -1
    s_cbranch_scc0 L_Anospec
ds_write_b128 v63, v[196:199] offset:0
ds_write_b128 v63, v[200:203] offset:4096
ds_write_b128 v63, v[204:207] offset:8192
ds_write_b128 v63, v[208:211] offset:12288
ds_write_b128 v63, v[212:215] offset:16384
ds_write_b128 v63, v[216:219] offset:20480
ds_write_b128 v63, v[220:223] offset:24576
ds_write_b128 v63, v[224:227] offset:28672
v_max3_u32 v44, v196, v197, v198
v_max3_u32 v44, v44, v199, v200
v_max3_u32 v44, v44, v201, v202
v_max3_u32 v44, v44, v203, v204
v_max3_u32 v44, v44, v205, v206
v_max3_u32 v44, v44, v207, v208
v_max3_u32 v44, v44, v209, v210
v_max3_u32 v44, v44, v211, v212
v_max3_u32 v44, v44, v213, v214
v_max3_u32 v44, v44, v215, v216
v_max3_u32 v44, v44, v217, v218
v_max3_u32 v44, v44, v219, v220
v_max3_u32 v44, v44, v221, v222
v_max3_u32 v44, v44, v223, v224
v_max3_u32 v44, v44, v225, v226
v_max_u32 v44, v44, v227
v_cmp_ne_u32 vcc, -1, v44
    s_nop 0
s_cmp_eq_u64 vcc, exec
    s_cbranch_scc1 L_Astaged
L_Anospec:
s_mov_b32 s15, 200000
Lp_3:
buffer_load_dword v196, v61, s[44:47], s5 offen sc1
s_waitcnt vmcnt(0)
v_cmp_eq_u32 vcc, s4, v196
    s_nop 0
s_andn2_b64 exec, exec, vcc
    s_cbranch_execz Ld_4
s_sub_u32 s15, s15, 1
    s_cmp_lg_u32 s15, 0
    s_cbranch_scc1 Lp_3
Ld_4:
s_mov_b64 exec, -1
s_mov_b32 s15, 200000
Lp_5:
buffer_load_dwordx4 v[196:199], v62, s[44:47], s13 offen offset:0 sc1
buffer_load_dwordx4 v[200:203], v62, s[44:47], s13 offen offset:128 sc1
buffer_load_dwordx4 v[204:207], v62, s[44:47], s13 offen offset:256 sc1
buffer_load_dwordx4 v[208:211], v62, s[44:47], s13 offen offset:384 sc1
buffer_load_dwordx4 v[212:215], v62, s[44:47], s13 offen offset:512 sc1
buffer_load_dwordx4 v[216:219], v62, s[44:47], s13 offen offset:640 sc1
buffer_load_dwordx4 v[220:223], v62, s[44:47], s13 offen offset:768 sc1
buffer_load_dwordx4 v[224:227], v62, s[44:47], s13 offen offset:896 sc1
s_waitcnt vmcnt(0)
v_max3_u32 v44, v196, v197, v198
v_max3_u32 v44, v44, v199, v200
v_max3_u32 v44, v44, v201, v202
v_max3_u32 v44, v44, v203, v204
v_max3_u32 v44, v44, v205, v206
v_max3_u32 v44, v44, v207, v208
v_max3_u32 v44, v44, v209, v210
v_max3_u32 v44, v44, v211, v212
v_max3_u32 v44, v44, v213, v214
v_max3_u32 v44, v44, v215, v216
v_max3_u32 v44, v44, v217, v218
v_max3_u32 v44, v44, v219, v220
v_max3_u32 v44, v44, v221, v222
v_max3_u32 v44, v44, v223, v224
v_max3_u32 v44, v44, v225, v226
v_max_u32 v44, v44, v227
v_cmp_ne_u32 vcc, -1, v44
    s_nop 0
s_andn2_b64 exec, exec, vcc
    s_cbranch_execz Ld_6
s_sub_u32 s15, s15, 1
    s_cmp_lg_u32 s15, 0
    s_cbranch_scc1 Lp_5
Ld_6:
s_mov_b64 exec, -1
ds_write_b128 v63, v[196:199] offset:0
ds_write_b128 v63, v[200:203] offset:4096
ds_write_b128 v63, v[204:207] offset:8192
ds_write_b128 v63, v[208:211] offset:12288
ds_write_b128 v63, v[212:215] offset:16384
ds_write_b128 v63, v[216:219] offset:20480
ds_write_b128 v63, v[220:223] offset:24576
ds_write_b128 v63, v[224:227] offset:28672
L_Astaged:
ds_read_b128 v[160:163], v28 offset:0
ds_read_b128 v[164:167], v29 offset:0
ds_read_b128 v[168:171], v30 offset:0
ds_read_b128 v[172:175], v31 offset:0
ds_read_b128 v[176:179], v32 offset:0
s_waitcnt lgkmcnt(0)
    s_barrier
ds_read_b128 v[196:199], v20 offset:0
ds_read_b128 v[200:203], v21 offset:512
ds_read_b128 v[204:207], v22 offset:1024
ds_read_b128 v[208:211], v23 offset:1536
ds_read_b128 v[236:239], v24 offset:2048
s_waitcnt lgkmcnt(4)
v_mfma_f32_32x32x16_bf16 v[44:59], v[160:163], v[196:199], 0
ds_read_b128 v[180:183], v33 offset:0
ds_read_b128 v[240:243], v25 offset:2560
s_add_u32 s14, s7, 0
buffer_load_dwordx4 v[128:131], v14, s[52:55], s14 offen nt
s_waitcnt lgkmcnt(5)
s_barrier
v_mfma_f32_32x32x16_bf16 v[44:59], v[164:167], v[200:203], v[44:59]
ds_read_b128 v[160:163], v34 offset:0
ds_read_b128 v[196:199], v26 offset:3072
s_waitcnt lgkmcnt(6)
v_mfma_f32_32x32x16_bf16 v[44:59], v[168:171], v[204:207], v[44:59]
ds_read_b128 v[164:167], v35 offset:0
ds_read_b128 v[200:203], v27 offset:3584
s_add_u32 s14, s7, 262144
buffer_load_dwordx4 v[132:135], v14, s[52:55], s14 offen nt
s_waitcnt lgkmcnt(7)
v_mfma_f32_32x32x16_bf16 v[44:59], v[172:175], v[208:211], v[44:59]
ds_read_b128 v[168:171], v36 offset:0
ds_read_b128 v[204:207], v20 offset:4096
s_waitcnt lgkmcnt(8)
v_mfma_f32_32x32x16_bf16 v[44:59], v[176:179], v[236:239], v[44:59]
ds_read_b128 v[172:175], v37 offset:0
ds_read_b128 v[208:211], v21 offset:4608
s_add_u32 s14, s7, 131072
buffer_load_dwordx4 v[136:139], v14, s[52:55], s14 offen nt
s_waitcnt lgkmcnt(8)
v_mfma_f32_32x32x16_bf16 v[44:59], v[180:183], v[240:243], v[44:59]
ds_read_b128 v[176:179], v38 offset:0
ds_read_b128 v[236:239], v22 offset:5120
s_waitcnt lgkmcnt(8)
v_mfma_f32_32x32x16_bf16 v[44:59], v[160:163], v[196:199], v[44:59]
ds_read_b128 v[180:183], v39 offset:0
ds_read_b128 v[240:243], v23 offset:5632
s_add_u32 s14, s7, 393216
buffer_load_dwordx4 v[140:143], v14, s[52:55], s14 offen nt
s_waitcnt lgkmcnt(8)
v_mfma_f32_32x32x16_bf16 v[44:59], v[164:167], v[200:203], v[44:59]
ds_read_b128 v[160:163], v40 offset:0
ds_read_b128 v[196:199], v24 offset:6144
s_waitcnt lgkmcnt(8)
v_mfma_f32_32x32x16_bf16 v[44:59], v[168:171], v[204:207], v[44:59]
ds_read_b128 v[164:167], v41 offset:0
ds_read_b128 v[200:203], v25 offset:6656
s_add_u32 s14, s7, 8192
buffer_load_dwordx4 v[144:147], v14, s[52:55], s14 offen nt
s_waitcnt lgkmcnt(8)
v_mfma_f32_32x32x16_bf16 v[44:59], v[172:175], v[208:211], v[44:59]
ds_read_b128 v[168:171], v42 offset:0
ds_read_b128 v[204:207], v26 offset:7168
s_waitcnt lgkmcnt(8)
v_mfma_f32_32x32x16_bf16 v[44:59], v[176:179], v[236:239], v[44:59]
ds_read_b128 v[172:175], v43 offset:0
ds_read_b128 v[208:211], v27 offset:7680
s_add_u32 s14, s7, 270336
buffer_load_dwordx4 v[148:151], v14, s[52:55], s14 offen nt
s_waitcnt lgkmcnt(8)
v_mfma_f32_32x32x16_bf16 v[44:59], v[180:183], v[240:243], v[44:59]
ds_read_b128 v[176:179], v28 offset:256
ds_read_b128 v[236:239], v20 offset:8192
s_waitcnt lgkmcnt(8)
v_mfma_f32_32x32x16_bf16 v[44:59], v[160:163], v[196:199], v[44:59]
ds_read_b128 v[180:183], v29 offset:256
ds_read_b128 v[240:243], v21 offset:8704
s_add_u32 s14, s7, 139264
buffer_load_dwordx4 v[152:155], v14, s[52:55], s14 offen nt
s_waitcnt lgkmcnt(8)
v_mfma_f32_32x32x16_bf16 v[44:59], v[164:167], v[200:203], v[44:59]
ds_read_b128 v[160:163], v30 offset:256
ds_read_b128 v[196:199], v22 offset:9216
s_waitcnt lgkmcnt(8)
v_mfma_f32_32x32x16_bf16 v[44:59], v[168:171], v[204:207], v[44:59]
ds_read_b128 v[164:167], v31 offset:256
ds_read_b128 v[200:203], v23 offset:9728
s_add_u32 s14, s7, 401408
buffer_load_dwordx4 v[156:159], v14, s[52:55], s14 offen nt
s_waitcnt lgkmcnt(8)
v_mfma_f32_32x32x16_bf16 v[44:59], v[172:175], v[208:211], v[44:59]
ds_read_b128 v[168:171], v32 offset:256
ds_read_b128 v[204:207], v24 offset:10240
s_waitcnt lgkmcnt(8)
v_mfma_f32_32x32x16_bf16 v[44:59], v[176:179], v[236:239], v[44:59]
ds_read_b128 v[172:175], v33 offset:256
ds_read_b128 v[208:211], v25 offset:10752
s_waitcnt lgkmcnt(8)
v_mfma_f32_32x32x16_bf16 v[44:59], v[180:183], v[240:243], v[44:59]
ds_read_b128 v[176:179], v34 offset:256
ds_read_b128 v[236:239], v26 offset:11264
s_waitcnt lgkmcnt(8)
v_mfma_f32_32x32x16_bf16 v[44:59], v[160:163], v[196:199], v[44:59]
ds_read_b128 v[180:183], v35 offset:256
ds_read_b128 v[240:243], v27 offset:11776
s_waitcnt lgkmcnt(8)
v_mfma_f32_32x32x16_bf16 v[44:59], v[164:167], v[200:203], v[44:59]
ds_read_b128 v[160:163], v36 offset:256
ds_read_b128 v[196:199], v20 offset:12288
s_waitcnt lgkmcnt(8)
v_mfma_f32_32x32x16_bf16 v[44:59], v[168:171], v[204:207], v[44:59]
ds_read_b128 v[164:167], v37 offset:256
ds_read_b128 v[200:203], v21 offset:12800
s_waitcnt lgkmcnt(8)
v_mfma_f32_32x32x16_bf16 v[44:59], v[172:175], v[208:211], v[44:59]
ds_read_b128 v[168:171], v38 offset:256
ds_read_b128 v[204:207], v22 offset:13312
s_waitcnt lgkmcnt(8)
v_mfma_f32_32x32x16_bf16 v[44:59], v[176:179], v[236:239], v[44:59]
ds_read_b128 v[172:175], v39 offset:256
ds_read_b128 v[208:211], v23 offset:13824
s_waitcnt lgkmcnt(8)
v_mfma_f32_32x32x16_bf16 v[44:59], v[180:183], v[240:243], v[44:59]
ds_read_b128 v[176:179], v40 offset:256
ds_read_b128 v[236:239], v24 offset:14336
s_waitcnt lgkmcnt(8)
v_mfma_f32_32x32x16_bf16 v[44:59], v[160:163], v[196:199], v[44:59]
ds_read_b128 v[180:183], v41 offset:256
ds_read_b128 v[240:243], v25 offset:14848
s_waitcnt lgkmcnt(8)
v_mfma_f32_32x32x16_bf16 v[44:59], v[164:167], v[200:203], v[44:59]
ds_read_b128 v[160:163], v42 offset:256
ds_read_b128 v[196:199], v26 offset:15360
s_waitcnt lgkmcnt(8)
v_mfma_f32_32x32x16_bf16 v[44:59], v[168:171], v[204:207], v[44:59]
ds_read_b128 v[164:167], v43 offset:256
ds_read_b128 v[200:203], v27 offset:15872
s_waitcnt lgkmcnt(8)
v_mfma_f32_32x32x16_bf16 v[44:59], v[172:175], v[208:211], v[44:59]
s_waitcnt lgkmcnt(6)
v_mfma_f32_32x32x16_bf16 v[44:59], v[176:179], v[236:239], v[44:59]
ds_read_b64_tr_b16 v[212:213], v4 offset:0
ds_read_b64_tr_b16 v[214:215], v5 offset:8192
s_waitcnt lgkmcnt(6)
v_mfma_f32_32x32x16_bf16 v[44:59], v[180:183], v[240:243], v[44:59]
ds_read_b64_tr_b16 v[216:217], v6 offset:0
ds_read_b64_tr_b16 v[218:219], v7 offset:8192
s_waitcnt lgkmcnt(6)
v_mfma_f32_32x32x16_bf16 v[44:59], v[160:163], v[196:199], v[44:59]
ds_read_b64_tr_b16 v[220:221], v4 offset:16384
ds_read_b64_tr_b16 v[222:223], v5 offset:24576
s_waitcnt lgkmcnt(6)
v_mfma_f32_32x32x16_bf16 v[44:59], v[164:167], v[200:203], v[44:59]
ds_read_b64_tr_b16 v[224:225], v6 offset:16384
ds_read_b64_tr_b16 v[226:227], v7 offset:24576
v_and_b32 v18, 31, v0
    v_lshlrev_b32 v19, 4, v18
    v_add_u32 v19, 131072, v19
    v_lshl_add_u32 v20, s3, 2, v19
    v_lshlrev_b32 v18, 5, v18
    v_add_u32 v21, 143360, v18
    v_lshrrev_b32 v18, 5, v0
    v_lshl_add_u32 v18, s3, 1, v18
    v_lshl_add_u32 v22, v18, 2, v21
    v_lshl_add_u32 v23, s3, 11, v12
    v_max3_f32 v16, v44, v45, v46
    v_max3_f32 v17, v47, v48, v49
v_max3_f32 v16, v16, v50, v51
v_max3_f32 v17, v17, v52, v53
v_max3_f32 v16, v16, v54, v55
v_max3_f32 v17, v17, v56, v57
v_max3_f32 v16, v16, v58, v59
    v_max_f32 v16, v16, v17
    v_mov_b32 v17, v16
    s_nop 1
    v_permlane32_swap_b32 v16, v17
    v_max_f32 v16, v16, v17
    ds_write_b32 v20, v16
    s_waitcnt lgkmcnt(0)
    s_barrier
ds_read_b128 v[28:31], v19
    s_waitcnt lgkmcnt(0)
    v_max3_f32 v28, v28, v29, v30
    v_max_f32 v24, v28, v31
v_sub_f32 v44, v44, v24
v_sub_f32 v45, v45, v24
v_sub_f32 v46, v46, v24
v_sub_f32 v47, v47, v24
v_sub_f32 v48, v48, v24
v_sub_f32 v49, v49, v24
v_sub_f32 v50, v50, v24
v_sub_f32 v51, v51, v24
v_exp_f32 v44, v44
v_exp_f32 v45, v45
v_exp_f32 v46, v46
v_exp_f32 v47, v47
v_exp_f32 v48, v48
v_exp_f32 v49, v49
v_exp_f32 v50, v50
v_exp_f32 v51, v51
v_cvt_pk_bf16_f32 v28, v44, v45
v_cvt_pk_bf16_f32 v29, v46, v47
v_cvt_pk_bf16_f32 v30, v48, v49
v_cvt_pk_bf16_f32 v31, v50, v51
ds_write_b128 v23, v[28:31] offset:0
v_sub_f32 v52, v52, v24
v_sub_f32 v53, v53, v24
v_sub_f32 v54, v54, v24
v_sub_f32 v55, v55, v24
v_sub_f32 v56, v56, v24
v_sub_f32 v57, v57, v24
v_sub_f32 v58, v58, v24
v_sub_f32 v59, v59, v24
v_exp_f32 v52, v52
v_exp_f32 v53, v53
v_exp_f32 v54, v54
v_exp_f32 v55, v55
v_exp_f32 v56, v56
v_exp_f32 v57, v57
v_exp_f32 v58, v58
v_exp_f32 v59, v59
v_cvt_pk_bf16_f32 v32, v52, v53
v_cvt_pk_bf16_f32 v33, v54, v55
v_cvt_pk_bf16_f32 v34, v56, v57
v_cvt_pk_bf16_f32 v35, v58, v59
ds_write_b128 v23, v[32:35] offset:1024
v_add_f32 v44, v44, v52
v_add_f32 v45, v45, v53
v_add_f32 v46, v46, v54
v_add_f32 v47, v47, v55
v_add_f32 v48, v48, v56
v_add_f32 v49, v49, v57
v_add_f32 v50, v50, v58
v_add_f32 v51, v51, v59
s_waitcnt lgkmcnt(0)
    s_barrier
    ds_read_b128 v[160:163], v12
    ds_read_b128 v[164:167], v12 offset:1024
s_waitcnt lgkmcnt(1)
v_mfma_f32_32x32x16_bf16 v[64:79], v[160:163], v[212:215], 0
ds_read_b128 v[168:171], v12 offset:2048
ds_read_b64_tr_b16 v[228:229], v4 offset:32768
ds_read_b64_tr_b16 v[230:231], v5 offset:40960
v_mfma_f32_32x32x16_bf16 v[80:95], v[160:163], v[216:219], 0
ds_read_b64_tr_b16 v[232:233], v6 offset:32768
ds_read_b64_tr_b16 v[234:235], v7 offset:40960
s_waitcnt lgkmcnt(5)
v_mfma_f32_32x32x16_bf16 v[64:79], v[164:167], v[220:223], v[64:79]
ds_read_b128 v[172:175], v12 offset:3072
ds_read_b64_tr_b16 v[236:237], v4 offset:49152
ds_read_b64_tr_b16 v[238:239], v5 offset:57344
v_mfma_f32_32x32x16_bf16 v[80:95], v[164:167], v[224:227], v[80:95]
ds_read_b64_tr_b16 v[240:241], v6 offset:49152
ds_read_b64_tr_b16 v[242:243], v7 offset:57344
v_add_f32 v44, v44, v48
v_add_f32 v45, v45, v49
v_add_f32 v46, v46, v50
v_add_f32 v47, v47, v51
s_waitcnt lgkmcnt(7)
v_mfma_f32_32x32x16_bf16 v[64:79], v[168:171], v[228:231], v[64:79]
ds_read_b128 v[176:179], v12 offset:4096
v_xor_b32 v4, 0x10000, v4
ds_read_b64_tr_b16 v[212:213], v4 offset:0
v_xor_b32 v5, 0x10000, v5
ds_read_b64_tr_b16 v[214:215], v5 offset:8192
s_waitcnt lgkmcnt(8)
v_mfma_f32_32x32x16_bf16 v[80:95], v[168:171], v[232:235], v[80:95]
v_xor_b32 v6, 0x10000, v6
ds_read_b64_tr_b16 v[216:217], v6 offset:0
v_xor_b32 v7, 0x10000, v7
ds_read_b64_tr_b16 v[218:219], v7 offset:8192
v_add_f32 v44, v44, v46
    v_add_f32 v45, v45, v47
s_waitcnt lgkmcnt(7)
v_mfma_f32_32x32x16_bf16 v[64:79], v[172:175], v[236:239], v[64:79]
ds_read_b128 v[180:183], v12 offset:5120
ds_read_b64_tr_b16 v[220:221], v4 offset:16384
ds_read_b64_tr_b16 v[222:223], v5 offset:24576
s_waitcnt lgkmcnt(8)
v_mfma_f32_32x32x16_bf16 v[80:95], v[172:175], v[240:243], v[80:95]
ds_read_b64_tr_b16 v[224:225], v6 offset:16384
ds_read_b64_tr_b16 v[226:227], v7 offset:24576
v_add_f32 v44, v44, v45
    v_mov_b32 v60, v24
s_waitcnt lgkmcnt(7)
v_mfma_f32_32x32x16_bf16 v[64:79], v[176:179], v[212:215], v[64:79]
ds_read_b128 v[184:187], v12 offset:6144
ds_read_b64_tr_b16 v[228:229], v4 offset:32768
ds_read_b64_tr_b16 v[230:231], v5 offset:40960
s_waitcnt lgkmcnt(8)
v_mfma_f32_32x32x16_bf16 v[80:95], v[176:179], v[216:219], v[80:95]
ds_read_b64_tr_b16 v[232:233], v6 offset:32768
ds_read_b64_tr_b16 v[234:235], v7 offset:40960
ds_write_b32 v22, v44
s_waitcnt lgkmcnt(7)
v_mfma_f32_32x32x16_bf16 v[64:79], v[180:183], v[220:223], v[64:79]
ds_read_b128 v[188:191], v12 offset:7168
ds_read_b64_tr_b16 v[236:237], v4 offset:49152
ds_read_b64_tr_b16 v[238:239], v5 offset:57344
s_waitcnt lgkmcnt(8)
v_mfma_f32_32x32x16_bf16 v[80:95], v[180:183], v[224:227], v[80:95]
ds_read_b64_tr_b16 v[240:241], v6 offset:49152
ds_read_b64_tr_b16 v[242:243], v7 offset:57344
v_mov_b32 v61, s4
    v_mov_b32 v63, s4
s_waitcnt lgkmcnt(7)
v_mfma_f32_32x32x16_bf16 v[64:79], v[184:187], v[228:231], v[64:79]
ds_read_b64_tr_b16 v[212:213], v8 offset:0
ds_read_b64_tr_b16 v[214:215], v9 offset:8192
v_and_b32 v16, 1, v1
    v_lshrrev_b32 v17, 1, v1
    v_lshl_add_u32 v16, v17, 2, v16
s_waitcnt lgkmcnt(7)
v_mfma_f32_32x32x16_bf16 v[80:95], v[184:187], v[232:235], v[80:95]
ds_read_b64_tr_b16 v[216:217], v10 offset:0
ds_read_b64_tr_b16 v[218:219], v11 offset:8192
v_lshlrev_b32 v16, 10, v16
    v_lshl_add_u32 v16, v2, 3, v16
    s_add_u32 s5, s3, 0
    s_and_b32 s5, s5, 3
    v_lshl_add_u32 v16, s5, 8, v16
s_waitcnt lgkmcnt(6)
v_mfma_f32_32x32x16_bf16 v[64:79], v[188:191], v[236:239], v[64:79]
ds_read_b64_tr_b16 v[220:221], v8 offset:16384
ds_read_b64_tr_b16 v[222:223], v9 offset:24576
s_lshl_b32 s5, s6, 15
    s_add_u32 s5, s5, 4194304
    s_add_u32 s12, s5, 8192
    s_add_u32 s13, s5, 16384
    s_add_u32 s74, s5, 24576
s_waitcnt lgkmcnt(6)
v_mfma_f32_32x32x16_bf16 v[80:95], v[188:191], v[240:243], v[80:95]
ds_read_b64_tr_b16 v[224:225], v10 offset:16384
ds_read_b64_tr_b16 v[226:227], v11 offset:24576
s_waitcnt lgkmcnt(6)
v_mfma_f32_32x32x16_bf16 v[96:111], v[160:163], v[212:215], 0
ds_read_b64_tr_b16 v[228:229], v8 offset:32768
ds_read_b64_tr_b16 v[230:231], v9 offset:40960
s_waitcnt lgkmcnt(6)
v_mfma_f32_32x32x16_bf16 v[112:127], v[160:163], v[216:219], 0
ds_read_b64_tr_b16 v[232:233], v10 offset:32768
ds_read_b64_tr_b16 v[234:235], v11 offset:40960
    s_nop 1
v_cvt_pk_bf16_f32 v52, v64, v80
    v_cvt_pk_bf16_f32 v53, v65, v81
s_waitcnt lgkmcnt(6)
v_mfma_f32_32x32x16_bf16 v[96:111], v[164:167], v[220:223], v[96:111]
ds_read_b64_tr_b16 v[236:237], v8 offset:49152
ds_read_b64_tr_b16 v[238:239], v9 offset:57344
v_permlane16_swap_b32 v52, v53
    buffer_store_dwordx2 v[52:53], v16, s[44:47], s5 offen offset:0 sc1
s_waitcnt lgkmcnt(6)
v_mfma_f32_32x32x16_bf16 v[112:127], v[164:167], v[224:227], v[112:127]
ds_read_b64_tr_b16 v[240:241], v10 offset:49152
ds_read_b64_tr_b16 v[242:243], v11 offset:57344
v_cvt_pk_bf16_f32 v54, v66, v82
    v_cvt_pk_bf16_f32 v55, v67, v83
s_waitcnt lgkmcnt(6)
v_mfma_f32_32x32x16_bf16 v[96:111], v[168:171], v[228:231], v[96:111]
v_xor_b32 v8, 0x10000, v8
ds_read_b64_tr_b16 v[212:213], v8 offset:0
v_xor_b32 v9, 0x10000, v9
ds_read_b64_tr_b16 v[214:215], v9 offset:8192
v_permlane16_swap_b32 v54, v55
    buffer_store_dwordx2 v[54:55], v16, s[44:47], s5 offen offset:2048 sc1
s_waitcnt lgkmcnt(6)
v_mfma_f32_32x32x16_bf16 v[112:127], v[168:171], v[232:235], v[112:127]
v_xor_b32 v10, 0x10000, v10
ds_read_b64_tr_b16 v[216:217], v10 offset:0
v_xor_b32 v11, 0x10000, v11
ds_read_b64_tr_b16 v[218:219], v11 offset:8192
v_cvt_pk_bf16_f32 v56, v68, v84
    v_cvt_pk_bf16_f32 v57, v69, v85
s_waitcnt lgkmcnt(6)
v_mfma_f32_32x32x16_bf16 v[96:111], v[172:175], v[236:239], v[96:111]
ds_read_b64_tr_b16 v[220:221], v8 offset:16384
ds_read_b64_tr_b16 v[222:223], v9 offset:24576
v_permlane16_swap_b32 v56, v57
    buffer_store_dwordx2 v[56:57], v16, s[44:47], s12 offen offset:0 sc1
s_waitcnt lgkmcnt(6)
v_mfma_f32_32x32x16_bf16 v[112:127], v[172:175], v[240:243], v[112:127]
ds_read_b64_tr_b16 v[224:225], v10 offset:16384
ds_read_b64_tr_b16 v[226:227], v11 offset:24576
v_cvt_pk_bf16_f32 v58, v70, v86
    v_cvt_pk_bf16_f32 v59, v71, v87
s_waitcnt lgkmcnt(6)
v_mfma_f32_32x32x16_bf16 v[96:111], v[176:179], v[212:215], v[96:111]
ds_read_b64_tr_b16 v[228:229], v8 offset:32768
ds_read_b64_tr_b16 v[230:231], v9 offset:40960
v_permlane16_swap_b32 v58, v59
    buffer_store_dwordx2 v[58:59], v16, s[44:47], s12 offen offset:2048 sc1
s_waitcnt lgkmcnt(6)
v_mfma_f32_32x32x16_bf16 v[112:127], v[176:179], v[216:219], v[112:127]
ds_read_b64_tr_b16 v[232:233], v10 offset:32768
ds_read_b64_tr_b16 v[234:235], v11 offset:40960
v_cvt_pk_bf16_f32 v52, v72, v88
    v_cvt_pk_bf16_f32 v53, v73, v89
s_waitcnt lgkmcnt(6)
v_mfma_f32_32x32x16_bf16 v[96:111], v[180:183], v[220:223], v[96:111]
ds_read_b64_tr_b16 v[236:237], v8 offset:49152
ds_read_b64_tr_b16 v[238:239], v9 offset:57344
v_permlane16_swap_b32 v52, v53
    buffer_store_dwordx2 v[52:53], v16, s[44:47], s13 offen offset:0 sc1
s_waitcnt lgkmcnt(6)
v_mfma_f32_32x32x16_bf16 v[112:127], v[180:183], v[224:227], v[112:127]
ds_read_b64_tr_b16 v[240:241], v10 offset:49152
ds_read_b64_tr_b16 v[242:243], v11 offset:57344
v_cvt_pk_bf16_f32 v54, v74, v90
    v_cvt_pk_bf16_f32 v55, v75, v91
s_waitcnt lgkmcnt(6)
v_mfma_f32_32x32x16_bf16 v[96:111], v[184:187], v[228:231], v[96:111]
v_permlane16_swap_b32 v54, v55
    buffer_store_dwordx2 v[54:55], v16, s[44:47], s13 offen offset:2048 sc1
s_waitcnt lgkmcnt(4)
v_mfma_f32_32x32x16_bf16 v[112:127], v[184:187], v[232:235], v[112:127]
v_cvt_pk_bf16_f32 v56, v76, v92
    v_cvt_pk_bf16_f32 v57, v77, v93
s_waitcnt lgkmcnt(2)
v_mfma_f32_32x32x16_bf16 v[96:111], v[188:191], v[236:239], v[96:111]
v_permlane16_swap_b32 v56, v57
    buffer_store_dwordx2 v[56:57], v16, s[44:47], s74 offen offset:0 sc1
s_waitcnt lgkmcnt(0)
s_barrier
v_mfma_f32_32x32x16_bf16 v[112:127], v[188:191], v[240:243], v[112:127]
v_cvt_pk_bf16_f32 v58, v78, v94
    v_cvt_pk_bf16_f32 v59, v79, v95
ds_read_b128 v[44:47], v21
    ds_read_b128 v[48:51], v21 offset:16
v_permlane16_swap_b32 v58, v59
    buffer_store_dwordx2 v[58:59], v16, s[44:47], s74 offen offset:2048 sc1
    s_nop 5
v_cvt_pk_bf16_f32 v52, v96, v112
    v_cvt_pk_bf16_f32 v53, v97, v113
v_cvt_pk_bf16_f32 v54, v98, v114
    v_cvt_pk_bf16_f32 v55, v99, v115
v_permlane16_swap_b32 v52, v53
    buffer_store_dwordx2 v[52:53], v16, s[44:47], s5 offen offset:128 sc1
v_cvt_pk_bf16_f32 v56, v100, v116
    v_cvt_pk_bf16_f32 v57, v101, v117
v_permlane16_swap_b32 v54, v55
    buffer_store_dwordx2 v[54:55], v16, s[44:47], s5 offen offset:2176 sc1
v_cvt_pk_bf16_f32 v58, v102, v118
    v_cvt_pk_bf16_f32 v59, v103, v119
v_permlane16_swap_b32 v56, v57
    buffer_store_dwordx2 v[56:57], v16, s[44:47], s12 offen offset:128 sc1
v_cvt_pk_bf16_f32 v52, v104, v120
    v_cvt_pk_bf16_f32 v53, v105, v121
v_permlane16_swap_b32 v58, v59
    buffer_store_dwordx2 v[58:59], v16, s[44:47], s12 offen offset:2176 sc1
v_cvt_pk_bf16_f32 v54, v106, v122
    v_cvt_pk_bf16_f32 v55, v107, v123
v_permlane16_swap_b32 v52, v53
    buffer_store_dwordx2 v[52:53], v16, s[44:47], s13 offen offset:128 sc1
v_cvt_pk_bf16_f32 v56, v108, v124
    v_cvt_pk_bf16_f32 v57, v109, v125
v_permlane16_swap_b32 v54, v55
    buffer_store_dwordx2 v[54:55], v16, s[44:47], s13 offen offset:2176 sc1
v_cvt_pk_bf16_f32 v58, v110, v126
    v_cvt_pk_bf16_f32 v59, v111, v127
v_permlane16_swap_b32 v56, v57
    buffer_store_dwordx2 v[56:57], v16, s[44:47], s74 offen offset:128 sc1
v_permlane16_swap_b32 v58, v59
    buffer_store_dwordx2 v[58:59], v16, s[44:47], s74 offen offset:2176 sc1
s_waitcnt lgkmcnt(0)
    v_add_f32 v44, v44, v45
    v_add_f32 v46, v46, v47
    v_add_f32 v48, v48, v49
    v_add_f32 v50, v50, v51
    v_add_f32 v44, v44, v46
    v_add_f32 v48, v48, v50
    v_add_f32 v62, v44, v48
s_lshl_b32 s5, s6, 9
    s_add_u32 s5, s5, 524288
    s_lshl_b32 s72, s3, 3
    s_lshl_b32 s72, 0xff, s72
s_lshr_b32 s9, s1, 2
    s_and_b32 s10, s1, 3
    v_and_b32 v16, 7, v0
    v_lshl_add_u32 v16, v16, 2, v1
    v_lshl_add_u32 v16, s3, 5, v16
    v_lshlrev_b32 v16, 9, v16
    v_lshlrev_b32 v17, 4, v2
    v_lshl_add_u32 v17, v1, 15, v17
    v_mov_b32 v18, s10
    v_and_b32 v18, 3, v18
    v_lshl_add_u32 v17, v18, 8, v17
    s_lshl_b32 s6, s9, 4
    s_lshl_b32 s14, s10, 9
    s_add_u32 s6, s6, 0
    s_add_u32 s6, s6, 524288
    s_lshl_b32 s11, s9, 10
    s_lshl_b32 s14, s3, 20
    s_add_u32 s11, s11, s14
    s_add_u32 s11, s11, 4194304
v_and_b32 v4, 7, v0
    v_lshl_add_u32 v4, v1, 3, v4
    v_lshlrev_b32 v4, 4, v4
    v_lshl_add_u32 v4, s3, 9, v4
s_lshl_b32 s14, s3, 3
    s_add_u32 s14, s14, 69632
    v_mov_b32 v7, s14
    v_and_b32 v18, 3, v0
    v_lshlrev_b32 v8, 3, v18
    v_add_u32 v8, 69632, v8
    v_lshl_add_u32 v9, s3, 10, v3
    v_add_u32 v9, 65536, v9
    v_bfe_u32 v10, v0, 2, 2
    v_lshlrev_b32 v10, 10, v10
    v_lshl_add_u32 v10, v18, 5, v10
    v_lshl_add_u32 v10, v1, 2, v10
    v_lshl_add_u32 v10, s3, 8, v10
    v_add_u32 v10, 65536, v10
    v_lshrrev_b32 v19, 3, v0
    v_lshlrev_b32 v11, 8, v19
    v_and_b32 v12, 7, v0
    v_lshl_add_u32 v11, v12, 4, v11
    v_add_u32 v11, 70656, v11
    v_lshlrev_b32 v12, 9, v18
    v_lshl_add_u32 v12, v19, 4, v12
    s_lshl_b32 s68, s1, 9
    s_add_u32 s68, s68, 786432
    s_lshl_b32 s69, s9, 11
    s_lshl_b32 s14, s10, 7
    s_add_u32 s69, s69, s14
    s_add_u32 s69, s69, 786432
    s_bitcmp1_b32 s3, 1
    s_cselect_b64 s[64:65], -1, 0
    s_bitcmp1_b32 s3, 0
    s_cselect_b32 s67, 0, 16
    s_mul_i32 s71, s2, 2304
    s_add_u32 s71, s71, 2097152
s_mov_b32 exec_hi, 0
s_waitcnt vmcnt(0)
s_barrier
    s_mov_b32 exec_lo, s72
buffer_store_dwordx4 v[60:63], v3, s[44:47], s5 offen sc1
    s_mov_b64 exec, -1
s_sleep 28
s_mov_b32 s15, 200000
Lp_7:
buffer_load_dwordx4 v[24:27], v16, s[44:47], s6 offen sc1
s_waitcnt vmcnt(0)
v_max_u32 v28, v25, v27
v_min_u32 v29, v25, v27
v_cmp_eq_u32 s[12:13], s4, v28
v_cmp_eq_u32 vcc, s4, v29
    s_nop 0
s_and_b64 vcc, vcc, s[12:13]
s_andn2_b64 exec, exec, vcc
    s_cbranch_execz Ld_8
s_sub_u32 s15, s15, 1
    s_cmp_lg_u32 s15, 0
    s_cbranch_scc1 Lp_7
Ld_8:
s_mov_b64 exec, -1
buffer_load_dwordx4 v[64:67], v17, s[44:47], s11 offen sc1
s_add_u32 s11, s11, 131072
buffer_load_dwordx4 v[68:71], v17, s[44:47], s11 offen sc1
s_add_u32 s11, s11, 131072
buffer_load_dwordx4 v[72:75], v17, s[44:47], s11 offen sc1
s_add_u32 s11, s11, 131072
buffer_load_dwordx4 v[76:79], v17, s[44:47], s11 offen sc1
s_add_u32 s11, s11, 131072
buffer_load_dwordx4 v[80:83], v17, s[44:47], s11 offen sc1
s_add_u32 s11, s11, 131072
buffer_load_dwordx4 v[84:87], v17, s[44:47], s11 offen sc1
s_add_u32 s11, s11, 131072
buffer_load_dwordx4 v[88:91], v17, s[44:47], s11 offen sc1
s_add_u32 s11, s11, 131072
buffer_load_dwordx4 v[92:95], v17, s[44:47], s11 offen sc1
v_mov_b32 v28, v24
    s_nop 1
v_max_f32_dpp v28, v28, v28 quad_perm:[1,0,3,2] row_mask:0xf bank_mask:0xf
    s_nop 1
v_max_f32_dpp v28, v28, v28 quad_perm:[2,3,0,1] row_mask:0xf bank_mask:0xf
    s_nop 1
v_max_f32_dpp v28, v28, v28 row_half_mirror row_mask:0xf bank_mask:0xf
v_mov_b32 v29, v28
    s_nop 1
    v_permlane16_swap_b32 v28, v29
    v_max_f32 v28, v28, v29
    v_mov_b32 v29, v28
    s_nop 1
    v_permlane32_swap_b32 v28, v29
    v_max_f32 v28, v28, v29
v_sub_f32 v30, v24, v28
    v_exp_f32 v30, v30
    s_nop 0
    v_mul_f32 v29, v26, v30
    s_nop 1
v_add_f32_dpp v29, v29, v29 quad_perm:[1,0,3,2] row_mask:0xf bank_mask:0xf
    s_nop 1
v_add_f32_dpp v29, v29, v29 quad_perm:[2,3,0,1] row_mask:0xf bank_mask:0xf
    s_nop 1
v_add_f32_dpp v29, v29, v29 row_half_mirror row_mask:0xf bank_mask:0xf
v_mov_b32 v30, v29
    s_nop 1
    v_permlane16_swap_b32 v29, v30
    v_add_f32 v29, v29, v30
    v_mov_b32 v30, v29
    s_nop 1
    v_permlane32_swap_b32 v29, v30
    v_add_f32 v29, v29, v30
ds_write_b64 v7, v[28:29]
    s_waitcnt lgkmcnt(0)
    s_barrier
    ds_read_b64 v[26:27], v8
s_waitcnt lgkmcnt(0)
    v_mov_b32 v28, v26
    s_nop 1
v_max_f32_dpp v28, v28, v28 quad_perm:[1,0,3,2] row_mask:0xf bank_mask:0xf
    s_nop 1
v_max_f32_dpp v28, v28, v28 quad_perm:[2,3,0,1] row_mask:0xf bank_mask:0xf
v_sub_f32 v26, v26, v28
    v_sub_f32 v30, v24, v28
    v_exp_f32 v26, v26
    v_exp_f32 v30, v30
    v_mul_f32 v27, v27, v26
    s_nop 1
v_add_f32_dpp v27, v27, v27 quad_perm:[1,0,3,2] row_mask:0xf bank_mask:0xf
    s_nop 1
v_add_f32_dpp v27, v27, v27 quad_perm:[2,3,0,1] row_mask:0xf bank_mask:0xf
v_rcp_f32 v27, v27
    s_nop 0
    v_mul_f32 v30, v30, v27
    v_cvt_pk_bf16_f32 v24, v30, v30
    v_lshlrev_b32 v24, 16, v24
    v_sub_f32 v25, v30, v24
    v_cvt_pk_bf16_f32 v32, v24, v25
    s_nop 1
v_mov_b32_dpp v18, v32 row_newbcast:0 row_mask:0xf bank_mask:0xf
v_perm_b32 v36, v18, v18, v244
v_perm_b32 v37, v18, v18, v245
v_perm_b32 v38, v18, v18, v246
v_perm_b32 v39, v18, v18, v247
v_mov_b32_dpp v18, v32 row_newbcast:1 row_mask:0xf bank_mask:0xf
v_perm_b32 v40, v18, v18, v244
v_perm_b32 v41, v18, v18, v245
v_perm_b32 v42, v18, v18, v246
v_perm_b32 v43, v18, v18, v247
s_waitcnt vmcnt(7)
v_mfma_f32_16x16x32_bf16 v[44:47], v[64:67], v[36:39], 0
buffer_load_dwordx4 v[160:163], v15, s[56:59], s8 offen offset:0 nt
v_mov_b32_dpp v18, v32 row_newbcast:2 row_mask:0xf bank_mask:0xf
v_perm_b32 v36, v18, v18, v244
v_perm_b32 v37, v18, v18, v245
v_perm_b32 v38, v18, v18, v246
v_perm_b32 v39, v18, v18, v247
s_waitcnt vmcnt(7)
v_mfma_f32_16x16x32_bf16 v[44:47], v[68:71], v[40:43], v[44:47]
s_add_u32 s14, s8, 9216
buffer_load_dwordx4 v[164:167], v15, s[56:59], s14 offen offset:0 nt
v_mov_b32_dpp v18, v32 row_newbcast:3 row_mask:0xf bank_mask:0xf
v_perm_b32 v40, v18, v18, v244
v_perm_b32 v41, v18, v18, v245
v_perm_b32 v42, v18, v18, v246
v_perm_b32 v43, v18, v18, v247
s_waitcnt vmcnt(7)
v_mfma_f32_16x16x32_bf16 v[44:47], v[72:75], v[36:39], v[44:47]
s_add_u32 s14, s8, 18432
buffer_load_dwordx4 v[168:171], v15, s[56:59], s14 offen offset:0 nt
v_mov_b32_dpp v18, v32 row_newbcast:4 row_mask:0xf bank_mask:0xf
v_perm_b32 v36, v18, v18, v244
v_perm_b32 v37, v18, v18, v245
v_perm_b32 v38, v18, v18, v246
v_perm_b32 v39, v18, v18, v247
s_waitcnt vmcnt(7)
v_mfma_f32_16x16x32_bf16 v[44:47], v[76:79], v[40:43], v[44:47]
s_add_u32 s14, s8, 27648
buffer_load_dwordx4 v[172:175], v15, s[56:59], s14 offen offset:0 nt
v_mov_b32_dpp v18, v32 row_newbcast:5 row_mask:0xf bank_mask:0xf
v_perm_b32 v40, v18, v18, v244
v_perm_b32 v41, v18, v18, v245
v_perm_b32 v42, v18, v18, v246
v_perm_b32 v43, v18, v18, v247
s_waitcnt vmcnt(7)
v_mfma_f32_16x16x32_bf16 v[44:47], v[80:83], v[36:39], v[44:47]
buffer_load_dwordx4 v[176:179], v15, s[56:59], s8 offen offset:128 nt
v_mov_b32_dpp v18, v32 row_newbcast:6 row_mask:0xf bank_mask:0xf
v_perm_b32 v36, v18, v18, v244
v_perm_b32 v37, v18, v18, v245
v_perm_b32 v38, v18, v18, v246
v_perm_b32 v39, v18, v18, v247
s_waitcnt vmcnt(7)
v_mfma_f32_16x16x32_bf16 v[44:47], v[84:87], v[40:43], v[44:47]
s_add_u32 s14, s8, 9216
buffer_load_dwordx4 v[180:183], v15, s[56:59], s14 offen offset:128 nt
v_mov_b32_dpp v18, v32 row_newbcast:7 row_mask:0xf bank_mask:0xf
v_perm_b32 v40, v18, v18, v244
v_perm_b32 v41, v18, v18, v245
v_perm_b32 v42, v18, v18, v246
v_perm_b32 v43, v18, v18, v247
s_waitcnt vmcnt(7)
v_mfma_f32_16x16x32_bf16 v[44:47], v[88:91], v[36:39], v[44:47]
s_add_u32 s14, s8, 18432
buffer_load_dwordx4 v[184:187], v15, s[56:59], s14 offen offset:128 nt
s_waitcnt vmcnt(7)
v_mfma_f32_16x16x32_bf16 v[44:47], v[92:95], v[40:43], v[44:47]
s_add_u32 s14, s8, 27648
buffer_load_dwordx4 v[188:191], v15, s[56:59], s14 offen offset:128 nt
    s_nop 5
ds_write_b128 v9, v[44:47]
s_cmp_lg_u32 s3, 0
    s_cbranch_scc1 L_Awx
buffer_load_dwordx4 v[192:195], v15, s[56:59], s8 offen offset:1024 nt
s_add_u32 s14, s8, 9216
buffer_load_dwordx4 v[196:199], v15, s[56:59], s14 offen offset:1024 nt
s_add_u32 s14, s8, 18432
buffer_load_dwordx4 v[200:203], v15, s[56:59], s14 offen offset:1024 nt
s_add_u32 s14, s8, 27648
buffer_load_dwordx4 v[204:207], v15, s[56:59], s14 offen offset:1024 nt
L_Awx:
s_waitcnt lgkmcnt(0)
    s_barrier
    ds_read_b32 v44, v10
    ds_read_b32 v45, v10 offset:16
    ds_read_b32 v46, v10 offset:128
    ds_read_b32 v47, v10 offset:144
    s_waitcnt lgkmcnt(0)
    v_add_f32 v44, v44, v46
    v_add_f32 v45, v45, v47
    s_nop 0
v_add_f32_dpp v44, v44, v44 row_ror:4 row_mask:0xf bank_mask:0xf
v_add_f32_dpp v45, v45, v45 row_ror:4 row_mask:0xf bank_mask:0xf
    s_nop 0
v_add_f32_dpp v44, v44, v44 row_ror:8 row_mask:0xf bank_mask:0xf
v_add_f32_dpp v45, v45, v45 row_ror:8 row_mask:0xf bank_mask:0xf
v_cvt_pk_bf16_f32 v32, v44, v45
    s_nop 1
v_mov_b32_dpp v18, v32 quad_perm:[0,0,0,0] row_mask:0xf bank_mask:0xf
v_perm_b32 v36, v18, v18, v248
v_perm_b32 v37, v18, v18, v249
v_perm_b32 v38, v18, v18, v250
v_perm_b32 v39, v18, v18, v251
v_perm_b32 v40, v18, v18, v252
v_perm_b32 v41, v18, v18, v253
v_perm_b32 v42, v18, v18, v254
v_perm_b32 v43, v18, v18, v255
v_mfma_f32_16x16x32_bf16 v[44:47], v[128:131], v[36:39], 0
v_mov_b32_dpp v18, v32 quad_perm:[1,1,1,1] row_mask:0xf bank_mask:0xf
v_perm_b32 v36, v18, v18, v248
v_perm_b32 v37, v18, v18, v249
v_perm_b32 v38, v18, v18, v250
v_perm_b32 v39, v18, v18, v251
v_mfma_f32_16x16x32_bf16 v[44:47], v[132:135], v[40:43], v[44:47]
v_perm_b32 v40, v18, v18, v252
v_perm_b32 v41, v18, v18, v253
v_perm_b32 v42, v18, v18, v254
v_perm_b32 v43, v18, v18, v255
v_mfma_f32_16x16x32_bf16 v[44:47], v[136:139], v[36:39], v[44:47]
v_mov_b32_dpp v18, v32 quad_perm:[2,2,2,2] row_mask:0xf bank_mask:0xf
v_perm_b32 v36, v18, v18, v248
v_perm_b32 v37, v18, v18, v249
v_perm_b32 v38, v18, v18, v250
v_perm_b32 v39, v18, v18, v251
v_mfma_f32_16x16x32_bf16 v[44:47], v[140:143], v[40:43], v[44:47]
v_perm_b32 v40, v18, v18, v252
v_perm_b32 v41, v18, v18, v253
v_perm_b32 v42, v18, v18, v254
v_perm_b32 v43, v18, v18, v255
v_mfma_f32_16x16x32_bf16 v[44:47], v[144:147], v[36:39], v[44:47]
v_mov_b32_dpp v18, v32 quad_perm:[3,3,3,3] row_mask:0xf bank_mask:0xf
v_perm_b32 v36, v18, v18, v248
v_perm_b32 v37, v18, v18, v249
v_perm_b32 v38, v18, v18, v250
v_perm_b32 v39, v18, v18, v251
v_mfma_f32_16x16x32_bf16 v[44:47], v[148:151], v[40:43], v[44:47]
v_perm_b32 v40, v18, v18, v252
v_perm_b32 v41, v18, v18, v253
v_perm_b32 v42, v18, v18, v254
v_perm_b32 v43, v18, v18, v255
v_mfma_f32_16x16x32_bf16 v[44:47], v[152:155], v[36:39], v[44:47]
    s_nop 0
v_mfma_f32_16x16x32_bf16 v[44:47], v[156:159], v[40:43], v[44:47]
    s_nop 7
ds_write_b128 v9, v[44:47] offset:5120
    s_waitcnt lgkmcnt(0)
    s_barrier
    s_cmp_lg_u32 s3, 0
    s_cbranch_scc1 L_Acx
    s_mov_b32 exec_hi, 0
ds_read_b128 v[64:67], v11 offset:0
ds_read_b128 v[68:71], v11 offset:1024
ds_read_b128 v[72:75], v11 offset:2048
ds_read_b128 v[76:79], v11 offset:3072
s_waitcnt lgkmcnt(2)
v_add_f32 v64, v64, v68
v_add_f32 v65, v65, v69
v_add_f32 v66, v66, v70
v_add_f32 v67, v67, v71
s_waitcnt lgkmcnt(0)
v_add_f32 v72, v72, v76
v_add_f32 v73, v73, v77
v_add_f32 v74, v74, v78
v_add_f32 v75, v75, v79
v_add_f32 v64, v64, v72
v_add_f32 v65, v65, v73
v_add_f32 v66, v66, v74
v_add_f32 v67, v67, v75
v_cvt_pk_bf16_f32 v64, v64, v65
    v_cvt_pk_bf16_f32 v66, v66, v67
    v_mov_b32 v65, s4
    v_mov_b32 v67, s4
    buffer_store_dwordx4 v[64:67], v3, s[44:47], s68 offen offset:0 sc1
s_mov_b32 exec_hi, -1
L_Acx:
s_sleep 10
s_mov_b32 s15, 200000
Lp_9:
buffer_load_dwordx4 v[44:47], v12, s[44:47], s69 offen sc1
s_waitcnt vmcnt(0)
v_max_u32 v28, v45, v47
v_min_u32 v29, v45, v47
v_cmp_eq_u32 s[12:13], s4, v28
v_cmp_eq_u32 vcc, s4, v29
    s_nop 0
s_and_b64 vcc, vcc, s[12:13]
s_andn2_b64 exec, exec, vcc
    s_cbranch_execz Ld_10
s_sub_u32 s15, s15, 1
    s_cmp_lg_u32 s15, 0
    s_cbranch_scc1 Lp_9
Ld_10:
s_mov_b64 exec, -1
v_and_b32 v45, 0xffff0000, v44
    v_lshlrev_b32 v44, 16, v44
    v_and_b32 v47, 0xffff0000, v46
    v_lshlrev_b32 v46, 16, v46
v_add_f32_dpp v44, v44, v44 quad_perm:[1,0,3,2] row_mask:0xf bank_mask:0xf
v_add_f32_dpp v45, v45, v45 quad_perm:[1,0,3,2] row_mask:0xf bank_mask:0xf
v_add_f32_dpp v46, v46, v46 quad_perm:[1,0,3,2] row_mask:0xf bank_mask:0xf
v_add_f32_dpp v47, v47, v47 quad_perm:[1,0,3,2] row_mask:0xf bank_mask:0xf
v_add_f32_dpp v44, v44, v44 quad_perm:[2,3,0,1] row_mask:0xf bank_mask:0xf
v_add_f32_dpp v45, v45, v45 quad_perm:[2,3,0,1] row_mask:0xf bank_mask:0xf
v_add_f32_dpp v46, v46, v46 quad_perm:[2,3,0,1] row_mask:0xf bank_mask:0xf
v_add_f32_dpp v47, v47, v47 quad_perm:[2,3,0,1] row_mask:0xf bank_mask:0xf
v_cvt_pk_bf16_f32 v44, v44, v45
    v_cvt_pk_bf16_f32 v45, v46, v47
v_perm_b32 v96, v44, v44, v248
v_perm_b32 v97, v44, v44, v249
v_perm_b32 v98, v44, v44, v250
v_perm_b32 v99, v44, v44, v251
v_perm_b32 v100, v44, v44, v252
v_perm_b32 v101, v44, v44, v253
v_perm_b32 v102, v44, v44, v254
v_perm_b32 v103, v44, v44, v255
v_mfma_f32_16x16x32_bf16 v[112:115], v[160:163], v[96:99], 0
v_mfma_f32_16x16x32_bf16 v[116:119], v[176:179], v[96:99], 0
v_perm_b32 v104, v45, v45, v248
v_perm_b32 v105, v45, v45, v249
v_perm_b32 v106, v45, v45, v250
v_perm_b32 v107, v45, v45, v251
v_mfma_f32_16x16x32_bf16 v[112:115], v[164:167], v[100:103], v[112:115]
v_mfma_f32_16x16x32_bf16 v[116:119], v[180:183], v[100:103], v[116:119]
v_perm_b32 v108, v45, v45, v252
v_perm_b32 v109, v45, v45, v253
v_perm_b32 v110, v45, v45, v254
v_perm_b32 v111, v45, v45, v255
v_mfma_f32_16x16x32_bf16 v[112:115], v[168:171], v[104:107], v[112:115]
v_mfma_f32_16x16x32_bf16 v[116:119], v[184:187], v[104:107], v[116:119]
v_mov_b32 v125, s4
    v_mov_b32 v127, s4
v_mfma_f32_16x16x32_bf16 v[112:115], v[172:175], v[108:111], v[112:115]
v_mfma_f32_16x16x32_bf16 v[116:119], v[188:191], v[108:111], v[116:119]
s_cmp_lg_u32 s3, 0
    s_cbranch_scc1 L_o1A
v_mfma_f32_16x16x32_bf16 v[120:123], v[192:195], v[96:99], 0
v_mfma_f32_16x16x32_bf16 v[120:123], v[196:199], v[100:103], v[120:123]
v_mfma_f32_16x16x32_bf16 v[120:123], v[200:203], v[104:107], v[120:123]
v_mfma_f32_16x16x32_bf16 v[120:123], v[204:207], v[108:111], v[120:123]
L_o1A:
s_nop 5
v_permlane32_swap_b32 v112, v116
v_permlane32_swap_b32 v113, v117
v_permlane32_swap_b32 v114, v118
v_permlane32_swap_b32 v115, v119
v_add_f32_dpp v112, v116, v112 row_ror:8 row_mask:0xf bank_mask:0xf
v_add_f32_dpp v113, v117, v113 row_ror:8 row_mask:0xf bank_mask:0xf
v_add_f32_dpp v114, v118, v114 row_ror:8 row_mask:0xf bank_mask:0xf
v_add_f32_dpp v115, v119, v115 row_ror:8 row_mask:0xf bank_mask:0xf
v_cvt_pk_bf16_f32 v124, v112, v113
    v_cvt_pk_bf16_f32 v126, v114, v115
s_mov_b32 exec_lo, 0x00ff00ff
    s_mov_b32 exec_hi, 0x00ff00ff
    buffer_store_dwordx4 v[124:127], v4, s[44:47], s71 offen sc1
    s_mov_b64 exec, -1
    s_cbranch_scc1 L_o2A
v_permlane32_swap_b32 v120, v116
v_permlane32_swap_b32 v121, v117
v_permlane32_swap_b32 v122, v118
v_permlane32_swap_b32 v123, v119
v_add_f32_dpp v120, v116, v120 row_ror:8 row_mask:0xf bank_mask:0xf
v_add_f32_dpp v121, v117, v121 row_ror:8 row_mask:0xf bank_mask:0xf
v_add_f32_dpp v122, v118, v122 row_ror:8 row_mask:0xf bank_mask:0xf
v_add_f32_dpp v123, v119, v123 row_ror:8 row_mask:0xf bank_mask:0xf
v_cvt_pk_bf16_f32 v124, v120, v121
    v_cvt_pk_bf16_f32 v126, v122, v123
s_mov_b32 exec_lo, 0x00ff00ff
    s_mov_b32 exec_hi, 0
    buffer_store_dwordx4 v[124:127], v4, s[44:47], s71 offen offset:2048 sc1
    s_mov_b64 exec, -1
L_o2A:
s_mov_b64 exec, -1
s_mov_b32 s60, s38
    s_and_b32 s61, s39, 0xffff
    s_mov_b32 s62, 2304
    s_mov_b32 s63, 0x20000
s_cmp_ge_u32 s2, 36
    s_cbranch_scc1 L_Aend
    s_cmp_ge_u32 s2, 18
    s_cselect_b32 s10, 18, 0
    s_cselect_b32 s11, 1152, 0
    s_cselect_b32 s14, 655360, 0
    s_sub_u32 s7, s2, s10
    s_lshl_b32 s5, s7, 7
    s_add_u32 s5, s5, s14
    s_mul_i32 s14, s3, 73728
    s_add_u32 s5, s5, s14
    s_add_u32 s5, s5, 2097152
    v_lshrrev_b32 v16, 3, v0
    v_mul_u32_u24 v16, 2304, v16
    v_and_b32 v17, 7, v0
    v_lshl_add_u32 v16, v17, 4, v16
    v_lshlrev_b32 v17, 4, v17
    v_lshl_add_u32 v17, s3, 7, v17
    v_add_u32 v17, 98304, v17
    v_and_b32 v18, 7, v0
    v_bfe_u32 v19, v0, 3, 2
    v_lshlrev_b32 v236, 4, v18
    v_lshl_add_u32 v236, v19, 2, v236
    v_add_u32 v236, 98304, v236
    s_lshl_b32 s7, s7, 6
    s_add_u32 s7, s7, s11
    v_lshlrev_b32 v18, 1, v0
    v_add_u32 v18, s7, v18
s_mov_b64 s[64:65], -1
s_mov_b64 s[66:67], -1
s_mov_b64 s[68:69], -1
s_mov_b64 s[70:71], -1
s_sleep 14
s_mov_b32 s15, 200000
L_Afp:
    s_mov_b32 s10, s5
s_mov_b64 exec, s[64:65]
    s_cbranch_execz L_Afp0
    buffer_load_dwordx4 v[196:199], v16, s[44:47], s10 offen sc1
L_Afp0:
s_add_u32 s10, s10, 18432
s_mov_b64 exec, s[66:67]
    s_cbranch_execz L_Afp1
    buffer_load_dwordx4 v[200:203], v16, s[44:47], s10 offen sc1
L_Afp1:
s_add_u32 s10, s10, 18432
s_mov_b64 exec, s[68:69]
    s_cbranch_execz L_Afp2
    buffer_load_dwordx4 v[204:207], v16, s[44:47], s10 offen sc1
L_Afp2:
s_add_u32 s10, s10, 18432
s_mov_b64 exec, s[70:71]
    s_cbranch_execz L_Afp3
    buffer_load_dwordx4 v[208:211], v16, s[44:47], s10 offen sc1
L_Afp3:
s_mov_b64 exec, -1
    s_mov_b64 s[80:81], 0
    s_waitcnt vmcnt(0)
v_cmp_ne_u32 s[12:13], s4, v197
    v_cmp_ne_u32 vcc, s4, v199
    s_nop 0
    s_or_b64 s[64:65], s[12:13], vcc
    s_or_b64 s[80:81], s[80:81], s[64:65]
v_cmp_ne_u32 s[12:13], s4, v201
    v_cmp_ne_u32 vcc, s4, v203
    s_nop 0
    s_or_b64 s[66:67], s[12:13], vcc
    s_or_b64 s[80:81], s[80:81], s[66:67]
v_cmp_ne_u32 s[12:13], s4, v205
    v_cmp_ne_u32 vcc, s4, v207
    s_nop 0
    s_or_b64 s[68:69], s[12:13], vcc
    s_or_b64 s[80:81], s[80:81], s[68:69]
v_cmp_ne_u32 s[12:13], s4, v209
    v_cmp_ne_u32 vcc, s4, v211
    s_nop 0
    s_or_b64 s[70:71], s[12:13], vcc
    s_or_b64 s[80:81], s[80:81], s[70:71]
s_cbranch_scc0 L_Afd
s_sub_u32 s15, s15, 1
    s_cmp_lg_u32 s15, 0
    s_cbranch_scc1 L_Afp
L_Afd:
v_and_b32 v197, 0xffff0000, v196
    v_lshlrev_b32 v196, 16, v196
    v_and_b32 v199, 0xffff0000, v198
    v_lshlrev_b32 v198, 16, v198
v_and_b32 v201, 0xffff0000, v200
    v_lshlrev_b32 v200, 16, v200
    v_and_b32 v203, 0xffff0000, v202
    v_lshlrev_b32 v202, 16, v202
v_and_b32 v205, 0xffff0000, v204
    v_lshlrev_b32 v204, 16, v204
    v_and_b32 v207, 0xffff0000, v206
    v_lshlrev_b32 v206, 16, v206
v_and_b32 v209, 0xffff0000, v208
    v_lshlrev_b32 v208, 16, v208
    v_and_b32 v211, 0xffff0000, v210
    v_lshlrev_b32 v210, 16, v210
v_add_f32 v196, v196, v200
v_add_f32 v204, v204, v208
v_add_f32 v197, v197, v201
v_add_f32 v205, v205, v209
v_add_f32 v198, v198, v202
v_add_f32 v206, v206, v210
v_add_f32 v199, v199, v203
v_add_f32 v207, v207, v211
v_add_f32 v196, v196, v204
v_add_f32 v197, v197, v205
v_add_f32 v198, v198, v206
v_add_f32 v199, v199, v207
v_add_f32_dpp v196, v196, v196 row_ror:8 row_mask:0xf bank_mask:0xf
v_add_f32_dpp v197, v197, v197 row_ror:8 row_mask:0xf bank_mask:0xf
v_add_f32_dpp v198, v198, v198 row_ror:8 row_mask:0xf bank_mask:0xf
v_add_f32_dpp v199, v199, v199 row_ror:8 row_mask:0xf bank_mask:0xf
v_permlane16_swap_b32 v196, v197
    s_nop 0
    v_permlane16_swap_b32 v198, v199
    v_add_f32 v196, v196, v197
    v_add_f32 v198, v198, v199
    s_nop 1
    v_permlane32_swap_b32 v196, v198
    v_add_f32 v196, v196, v198
    v_lshl_add_u32 v17, v1, 2, v17
    ds_write_b32 v17, v196
    s_waitcnt lgkmcnt(0)
    s_barrier
    s_cmp_lg_u32 s3, 0
    s_cbranch_scc1 L_Aend
ds_read_b32 v196, v236 offset:0
ds_read_b32 v197, v236 offset:128
ds_read_b32 v198, v236 offset:256
ds_read_b32 v199, v236 offset:384
s_mov_b32 exec_hi, 0
    s_waitcnt lgkmcnt(0)
    v_add_f32 v196, v196, v197
    v_add_f32 v198, v198, v199
    v_add_f32 v196, v196, v198
    v_cvt_pk_bf16_f32 v196, v196, v196
    buffer_store_short v196, v18, s[60:63], 0 offen
    s_cmp_lg_u32 s2, 18
    s_cbranch_scc1 L_Aend
    v_mov_b32 v16, s4
    v_mov_b32 v17, 0
    s_mov_b64 exec, 1
    buffer_store_dword v16, v17, s[44:47], 0 offen offset:0 sc1
L_Aend:
s_endpgm
L_comm:
v_bfe_u32 v17, v0, 3, 1
    v_lshl_add_u32 v18, v17, 3, v3
    v_lshlrev_b32 v17, 5, v17
    v_lshl_add_u32 v17, v1, 6, v17
    v_and_b32 v19, 7, v0
    v_lshl_add_u32 v17, v19, 1, v17
    s_cmp_ge_u32 s2, 128
    s_cbranch_scc1 L_commB
s_mov_b32 s48, s22
    s_and_b32 s49, s23, 0xffff
    s_mov_b32 s50, 4194304
    s_mov_b32 s51, 0x20000
s_lshl_b32 s5, s1, 8
    s_add_u32 s5, s5, 65536
    v_mov_b32 v24, -1
    v_mov_b32 v25, -1
    v_mov_b32 v26, -1
    v_mov_b32 v27, -1
    s_mov_b64 exec, 0xffff
    buffer_store_dwordx4 v[24:27], v3, s[44:47], s5 offen sc1
    s_mov_b64 exec, -1
    s_lshr_b32 s6, s1, 2
    s_and_b32 s7, s1, 3
    s_lshl_b32 s8, s7, 20
    s_lshl_b32 s9, s6, 8
    s_add_u32 s8, s8, s9
    v_xor_b32 v4, v2, v1
    v_lshlrev_b32 v4, 4, v4
    v_lshl_add_u32 v4, v1, 13, v4
v_xor_b32 v5, 64, v4
v_xor_b32 v6, 128, v4
v_xor_b32 v7, 192, v4
s_barrier
s_mov_b32 m0, 131072
    s_nop 0
buffer_load_dwordx4 v4, s[48:51], s8 offen nt lds
s_add_u32 s8, s8, 32768
s_mov_b32 m0, 132096
    s_nop 0
buffer_load_dwordx4 v5, s[48:51], s8 offen nt lds
s_add_u32 s8, s8, 32768
s_mov_b32 m0, 133120
    s_nop 0
buffer_load_dwordx4 v6, s[48:51], s8 offen nt lds
s_add_u32 s8, s8, 32768
s_mov_b32 m0, 134144
    s_nop 0
buffer_load_dwordx4 v7, s[48:51], s8 offen nt lds
s_add_u32 s8, s8, 32768
s_mov_b32 m0, 135168
    s_nop 0
buffer_load_dwordx4 v4, s[48:51], s8 offen nt lds
s_add_u32 s8, s8, 32768
s_mov_b32 m0, 136192
    s_nop 0
buffer_load_dwordx4 v5, s[48:51], s8 offen nt lds
s_add_u32 s8, s8, 32768
s_mov_b32 m0, 137216
    s_nop 0
buffer_load_dwordx4 v6, s[48:51], s8 offen nt lds
s_add_u32 s8, s8, 32768
s_mov_b32 m0, 138240
    s_nop 0
buffer_load_dwordx4 v7, s[48:51], s8 offen nt lds
s_add_u32 s8, s8, 32768
s_mov_b32 m0, 139264
    s_nop 0
buffer_load_dwordx4 v4, s[48:51], s8 offen nt lds
s_add_u32 s8, s8, 32768
s_mov_b32 m0, 140288
    s_nop 0
buffer_load_dwordx4 v5, s[48:51], s8 offen nt lds
s_add_u32 s8, s8, 32768
s_mov_b32 m0, 141312
    s_nop 0
buffer_load_dwordx4 v6, s[48:51], s8 offen nt lds
s_add_u32 s8, s8, 32768
s_mov_b32 m0, 142336
    s_nop 0
buffer_load_dwordx4 v7, s[48:51], s8 offen nt lds
s_add_u32 s8, s8, 32768
s_mov_b32 m0, 143360
    s_nop 0
buffer_load_dwordx4 v4, s[48:51], s8 offen nt lds
s_add_u32 s8, s8, 32768
s_mov_b32 m0, 144384
    s_nop 0
buffer_load_dwordx4 v5, s[48:51], s8 offen nt lds
s_add_u32 s8, s8, 32768
s_mov_b32 m0, 145408
    s_nop 0
buffer_load_dwordx4 v6, s[48:51], s8 offen nt lds
s_add_u32 s8, s8, 32768
s_mov_b32 m0, 146432
    s_nop 0
buffer_load_dwordx4 v7, s[48:51], s8 offen nt lds
s_add_u32 s8, s8, 32768
s_mov_b32 m0, 147456
    s_nop 0
buffer_load_dwordx4 v4, s[48:51], s8 offen nt lds
s_add_u32 s8, s8, 32768
s_mov_b32 m0, 148480
    s_nop 0
buffer_load_dwordx4 v5, s[48:51], s8 offen nt lds
s_add_u32 s8, s8, 32768
s_mov_b32 m0, 149504
    s_nop 0
buffer_load_dwordx4 v6, s[48:51], s8 offen nt lds
s_add_u32 s8, s8, 32768
s_mov_b32 m0, 150528
    s_nop 0
buffer_load_dwordx4 v7, s[48:51], s8 offen nt lds
s_add_u32 s8, s8, 32768
s_mov_b32 m0, 151552
    s_nop 0
buffer_load_dwordx4 v4, s[48:51], s8 offen nt lds
s_add_u32 s8, s8, 32768
s_mov_b32 m0, 152576
    s_nop 0
buffer_load_dwordx4 v5, s[48:51], s8 offen nt lds
s_add_u32 s8, s8, 32768
s_mov_b32 m0, 153600
    s_nop 0
buffer_load_dwordx4 v6, s[48:51], s8 offen nt lds
s_add_u32 s8, s8, 32768
s_mov_b32 m0, 154624
    s_nop 0
buffer_load_dwordx4 v7, s[48:51], s8 offen nt lds
s_add_u32 s8, s8, 32768
s_mov_b32 m0, 155648
    s_nop 0
buffer_load_dwordx4 v4, s[48:51], s8 offen nt lds
s_add_u32 s8, s8, 32768
s_mov_b32 m0, 156672
    s_nop 0
buffer_load_dwordx4 v5, s[48:51], s8 offen nt lds
s_add_u32 s8, s8, 32768
s_mov_b32 m0, 157696
    s_nop 0
buffer_load_dwordx4 v6, s[48:51], s8 offen nt lds
s_add_u32 s8, s8, 32768
s_mov_b32 m0, 158720
    s_nop 0
buffer_load_dwordx4 v7, s[48:51], s8 offen nt lds
s_add_u32 s8, s8, 32768
s_mov_b32 m0, 159744
    s_nop 0
buffer_load_dwordx4 v4, s[48:51], s8 offen nt lds
s_add_u32 s8, s8, 32768
s_mov_b32 m0, 160768
    s_nop 0
buffer_load_dwordx4 v5, s[48:51], s8 offen nt lds
s_add_u32 s8, s8, 32768
s_mov_b32 m0, 161792
    s_nop 0
buffer_load_dwordx4 v6, s[48:51], s8 offen nt lds
s_add_u32 s8, s8, 32768
s_mov_b32 m0, 162816
    s_nop 0
buffer_load_dwordx4 v7, s[48:51], s8 offen nt lds
s_add_u32 s8, s8, 32768
v_add_u32 v8, 0, v1
    v_xor_b32 v8, v8, v2
    v_lshlrev_b32 v8, 4, v8
    v_lshl_add_u32 v8, v2, 8, v8
    v_add_u32 v8, 131072, v8
v_add_u32 v9, 4, v1
    v_xor_b32 v9, v9, v2
    v_lshlrev_b32 v9, 4, v9
    v_lshl_add_u32 v9, v2, 8, v9
    v_add_u32 v9, 131072, v9
v_add_u32 v10, 8, v1
    v_xor_b32 v10, v10, v2
    v_lshlrev_b32 v10, 4, v10
    v_lshl_add_u32 v10, v2, 8, v10
    v_add_u32 v10, 131072, v10
v_add_u32 v11, 12, v1
    v_xor_b32 v11, v11, v2
    v_lshlrev_b32 v11, 4, v11
    v_lshl_add_u32 v11, v2, 8, v11
    v_add_u32 v11, 131072, v11
v_add_u32 v18, 31744, v18
    v_add_u32 v17, 131072, v17
    s_lshl_b32 s5, s0, 10
    s_add_u32 s5, s5, 131072
    s_waitcnt lgkmcnt(0)
    s_add_u32 s4, s4, 1
s_lshl_b32 s9, s6, 12
    s_add_u32 s9, s9, 131072
s_barrier
ds_read_b64 v[24:25], v18 offset:0
ds_read_b64 v[26:27], v18 offset:32768
v_add_u32 v18, 0x10000, v18
ds_read_b64 v[28:29], v18 offset:0
ds_read_b64 v[30:31], v18 offset:32768
s_waitcnt lgkmcnt(0)
    v_add_f32 v24, v24, v26
    v_add_f32 v28, v28, v30
    v_add_f32 v25, v25, v27
    v_add_f32 v29, v29, v31
    v_add_f32 v24, v24, v28
    v_add_f32 v26, v25, v29
    v_mov_b32 v25, s4
    v_mov_b32 v27, s4
    buffer_store_dwordx4 v[24:27], v3, s[44:47], s5 offen sc1
s_lshl_b32 s5, s1, 7
    s_add_u32 s5, s5, 32768
    v_mov_b32 v28, s4
    v_mov_b32 v29, s4
    v_mov_b32 v30, s4
    v_mov_b32 v31, s4
    s_mov_b64 exec, 0xff
    s_waitcnt vmcnt(33)
    buffer_store_dwordx4 v[28:31], v3, s[44:47], s5 offen sc1
    s_mov_b64 exec, -1
s_barrier
v_lshlrev_b32 v18, 4, v1
    v_add_u32 v18, 131072, v18
    v_and_b32 v19, 7, v0
v_cmp_eq_u32 s[64:65], 1, v19
v_cmp_eq_u32 s[66:67], 2, v19
v_cmp_eq_u32 s[68:69], 3, v19
v_cmp_eq_u32 s[70:71], 4, v19
v_cmp_eq_u32 s[72:73], 5, v19
v_cmp_eq_u32 s[74:75], 6, v19
v_cmp_eq_u32 s[76:77], 7, v19
v_lshlrev_b32 v19, 5, v19
    v_lshl_add_u32 v19, v1, 3, v19
    s_waitcnt vmcnt(2)
buffer_load_dwordx4 v[32:35], v3, s[44:47], s9 offen offset:0 sc1
buffer_load_dwordx4 v[36:39], v3, s[44:47], s9 offen offset:1024 sc1
buffer_load_dwordx4 v[40:43], v3, s[44:47], s9 offen offset:2048 sc1
buffer_load_dwordx4 v[44:47], v3, s[44:47], s9 offen offset:3072 sc1
ds_read_b128 v[128:131], v8 offset:0
ds_read_b128 v[132:135], v9 offset:0
ds_read_b128 v[136:139], v10 offset:0
ds_read_b128 v[140:143], v11 offset:0
ds_read_b128 v[144:147], v8 offset:4096
ds_read_b128 v[148:151], v9 offset:4096
ds_read_b128 v[152:155], v10 offset:4096
ds_read_b128 v[156:159], v11 offset:4096
ds_read_b128 v[160:163], v8 offset:8192
ds_read_b128 v[164:167], v9 offset:8192
ds_read_b128 v[168:171], v10 offset:8192
ds_read_b128 v[172:175], v11 offset:8192
ds_read_b128 v[176:179], v8 offset:12288
ds_read_b128 v[180:183], v9 offset:12288
ds_read_b128 v[184:187], v10 offset:12288
ds_read_b128 v[188:191], v11 offset:12288
ds_read_b128 v[192:195], v8 offset:16384
ds_read_b128 v[196:199], v9 offset:16384
ds_read_b128 v[200:203], v10 offset:16384
ds_read_b128 v[204:207], v11 offset:16384
ds_read_b128 v[208:211], v8 offset:20480
ds_read_b128 v[212:215], v9 offset:20480
ds_read_b128 v[216:219], v10 offset:20480
ds_read_b128 v[220:223], v11 offset:20480
ds_read_b128 v[224:227], v8 offset:24576
ds_read_b128 v[228:231], v9 offset:24576
ds_read_b128 v[232:235], v10 offset:24576
ds_read_b128 v[236:239], v11 offset:24576
ds_read_b128 v[240:243], v8 offset:28672
ds_read_b128 v[244:247], v9 offset:28672
ds_read_b128 v[248:251], v10 offset:28672
ds_read_b128 v[252:255], v11 offset:28672
s_waitcnt vmcnt(0)
v_max_u32 v64, v33, v35
v_min_u32 v65, v33, v35
v_max3_u32 v64, v64, v37, v39
v_min3_u32 v65, v65, v37, v39
v_max3_u32 v64, v64, v41, v43
v_min3_u32 v65, v65, v41, v43
v_max3_u32 v64, v64, v45, v47
v_min3_u32 v65, v65, v45, v47
v_cmp_eq_u32 s[12:13], s4, v64
v_cmp_eq_u32 vcc, s4, v65
    s_nop 0
s_and_b64 vcc, vcc, s[12:13]
s_andn2_b64 exec, exec, vcc
    s_cbranch_execz L_commq
s_mov_b32 s15, 200000
Lp_11:
buffer_load_dwordx4 v[32:35], v3, s[44:47], s9 offen offset:0 sc1
buffer_load_dwordx4 v[36:39], v3, s[44:47], s9 offen offset:1024 sc1
buffer_load_dwordx4 v[40:43], v3, s[44:47], s9 offen offset:2048 sc1
buffer_load_dwordx4 v[44:47], v3, s[44:47], s9 offen offset:3072 sc1
s_waitcnt vmcnt(0)
v_max_u32 v64, v33, v35
v_min_u32 v65, v33, v35
v_max3_u32 v64, v64, v37, v39
v_min3_u32 v65, v65, v37, v39
v_max3_u32 v64, v64, v41, v43
v_min3_u32 v65, v65, v41, v43
v_max3_u32 v64, v64, v45, v47
v_min3_u32 v65, v65, v45, v47
v_cmp_eq_u32 s[12:13], s4, v64
v_cmp_eq_u32 vcc, s4, v65
    s_nop 0
s_and_b64 vcc, vcc, s[12:13]
s_andn2_b64 exec, exec, vcc
    s_cbranch_execz Ld_12
s_sub_u32 s15, s15, 1
    s_cmp_lg_u32 s15, 0
    s_cbranch_scc1 Lp_11
Ld_12:
s_mov_b64 exec, -1
L_commq:
    s_mov_b64 exec, -1
v_add_f32 v32, v32, v36
v_add_f32 v40, v40, v44
v_add_f32 v32, v32, v40
v_add_f32 v34, v34, v38
v_add_f32 v42, v42, v46
v_add_f32 v34, v34, v42
v_cvt_pk_bf16_f32 v32, v32, v34
    s_waitcnt lgkmcnt(0)
    ds_write_b16 v17, v32
    ds_write_b16_d16_hi v17, v32 offset:16
    s_lshl_b32 s12, s1, 8
    s_add_u32 s12, s12, 65536
    s_lshl_b32 s5, s1, 7
    s_add_u32 s5, s5, 16384
    s_mov_b32 s14, 1040356334
    s_waitcnt lgkmcnt(0)
ds_read_b128 v[64:67], v18 offset:0
ds_read_b128 v[68:71], v18 offset:64
ds_read_b128 v[72:75], v18 offset:128
ds_read_b128 v[76:79], v18 offset:192
s_waitcnt lgkmcnt(0)
v_mfma_f32_16x16x32_bf16 v[80:83], v[128:131], v[64:67], 0
v_mfma_f32_16x16x32_bf16 v[80:83], v[132:135], v[68:71], v[80:83]
v_mfma_f32_16x16x32_bf16 v[80:83], v[136:139], v[72:75], v[80:83]
v_mfma_f32_16x16x32_bf16 v[80:83], v[140:143], v[76:79], v[80:83]
v_mfma_f32_16x16x32_bf16 v[84:87], v[144:147], v[64:67], 0
v_mfma_f32_16x16x32_bf16 v[84:87], v[148:151], v[68:71], v[84:87]
v_mfma_f32_16x16x32_bf16 v[84:87], v[152:155], v[72:75], v[84:87]
v_mfma_f32_16x16x32_bf16 v[84:87], v[156:159], v[76:79], v[84:87]
v_mfma_f32_16x16x32_bf16 v[88:91], v[160:163], v[64:67], 0
v_mfma_f32_16x16x32_bf16 v[88:91], v[164:167], v[68:71], v[88:91]
v_mfma_f32_16x16x32_bf16 v[88:91], v[168:171], v[72:75], v[88:91]
v_mfma_f32_16x16x32_bf16 v[88:91], v[172:175], v[76:79], v[88:91]
    s_nop 3
v_cndmask_b32 v80, v80, v84, s[64:65]
v_cndmask_b32 v81, v81, v85, s[64:65]
v_cndmask_b32 v82, v82, v86, s[64:65]
v_cndmask_b32 v83, v83, v87, s[64:65]
v_mfma_f32_16x16x32_bf16 v[92:95], v[176:179], v[64:67], 0
v_mfma_f32_16x16x32_bf16 v[92:95], v[180:183], v[68:71], v[92:95]
v_mfma_f32_16x16x32_bf16 v[92:95], v[184:187], v[72:75], v[92:95]
v_mfma_f32_16x16x32_bf16 v[92:95], v[188:191], v[76:79], v[92:95]
v_cndmask_b32 v80, v80, v88, s[66:67]
v_cndmask_b32 v81, v81, v89, s[66:67]
v_cndmask_b32 v82, v82, v90, s[66:67]
v_cndmask_b32 v83, v83, v91, s[66:67]
v_mfma_f32_16x16x32_bf16 v[96:99], v[192:195], v[64:67], 0
v_mfma_f32_16x16x32_bf16 v[96:99], v[196:199], v[68:71], v[96:99]
v_mfma_f32_16x16x32_bf16 v[96:99], v[200:203], v[72:75], v[96:99]
v_mfma_f32_16x16x32_bf16 v[96:99], v[204:207], v[76:79], v[96:99]
v_cndmask_b32 v80, v80, v92, s[68:69]
v_cndmask_b32 v81, v81, v93, s[68:69]
v_cndmask_b32 v82, v82, v94, s[68:69]
v_cndmask_b32 v83, v83, v95, s[68:69]
v_mfma_f32_16x16x32_bf16 v[100:103], v[208:211], v[64:67], 0
v_mfma_f32_16x16x32_bf16 v[100:103], v[212:215], v[68:71], v[100:103]
v_mfma_f32_16x16x32_bf16 v[100:103], v[216:219], v[72:75], v[100:103]
v_mfma_f32_16x16x32_bf16 v[100:103], v[220:223], v[76:79], v[100:103]
v_cndmask_b32 v80, v80, v96, s[70:71]
v_cndmask_b32 v81, v81, v97, s[70:71]
v_cndmask_b32 v82, v82, v98, s[70:71]
v_cndmask_b32 v83, v83, v99, s[70:71]
v_mfma_f32_16x16x32_bf16 v[104:107], v[224:227], v[64:67], 0
v_mfma_f32_16x16x32_bf16 v[104:107], v[228:231], v[68:71], v[104:107]
v_mfma_f32_16x16x32_bf16 v[104:107], v[232:235], v[72:75], v[104:107]
v_mfma_f32_16x16x32_bf16 v[104:107], v[236:239], v[76:79], v[104:107]
v_cndmask_b32 v80, v80, v100, s[72:73]
v_cndmask_b32 v81, v81, v101, s[72:73]
v_cndmask_b32 v82, v82, v102, s[72:73]
v_cndmask_b32 v83, v83, v103, s[72:73]
v_mfma_f32_16x16x32_bf16 v[108:111], v[240:243], v[64:67], 0
v_mfma_f32_16x16x32_bf16 v[108:111], v[244:247], v[68:71], v[108:111]
v_mfma_f32_16x16x32_bf16 v[108:111], v[248:251], v[72:75], v[108:111]
v_mfma_f32_16x16x32_bf16 v[108:111], v[252:255], v[76:79], v[108:111]
v_cndmask_b32 v80, v80, v104, s[74:75]
v_cndmask_b32 v81, v81, v105, s[74:75]
v_cndmask_b32 v82, v82, v106, s[74:75]
v_cndmask_b32 v83, v83, v107, s[74:75]
    s_nop 3
v_cndmask_b32 v80, v80, v108, s[76:77]
v_cndmask_b32 v81, v81, v109, s[76:77]
v_cndmask_b32 v82, v82, v110, s[76:77]
v_cndmask_b32 v83, v83, v111, s[76:77]
v_mul_f32 v80, s14, v80
v_mul_f32 v81, s14, v81
v_mul_f32 v82, s14, v82
v_mul_f32 v83, s14, v83
v_cvt_pk_bf16_f32 v80, v80, v81
    v_cvt_pk_bf16_f32 v81, v82, v83
    v_mov_b32 v82, v80
    v_mov_b32 v83, v81
    v_mov_b32 v84, v80
    v_mov_b32 v85, v81
    v_mov_b32 v88, s4
    v_permlane16_swap_b32 v84, v82
    v_permlane16_swap_b32 v85, v83
    v_mov_b32 v89, s4
    v_mov_b32 v90, s4
    v_mov_b32 v91, s4
    s_mov_b32 exec_lo, 0xff
    s_mov_b32 exec_hi, 0xff
    buffer_store_dwordx4 v[80:83], v19, s[44:47], s12 offen sc1
    s_mov_b64 exec, 0xff
    buffer_store_dwordx4 v[88:91], v3, s[44:47], s5 offen sc1
    s_mov_b64 exec, -1
s_endpgm
L_commB:
    v_add_u32 v18, 131072, v18
    v_add_u32 v17, 147712, v17
    s_sub_u32 s6, s2, 128
    s_xor_b32 s5, s6, 0
    s_lshl_b32 s5, s5, 10
    s_add_u32 s5, s5, 262144
s_waitcnt lgkmcnt(0)
    s_add_u32 s4, s4, 1
    s_barrier
ds_read_b64 v[24:25], v18 offset:0
ds_read_b64 v[26:27], v18 offset:1024
ds_read_b64 v[28:29], v18 offset:2048
ds_read_b64 v[30:31], v18 offset:3072
s_waitcnt lgkmcnt(0)
    v_add_f32 v24, v24, v26
    v_add_f32 v28, v28, v30
    v_add_f32 v25, v25, v27
    v_add_f32 v29, v29, v31
    v_add_f32 v24, v24, v28
    v_add_f32 v26, v25, v29
    v_mov_b32 v25, s4
    v_mov_b32 v27, s4
    buffer_store_dwordx4 v[24:27], v3, s[44:47], s5 offen sc1
s_cmp_ge_u32 s2, 136
    s_cbranch_scc1 L_nocp
    s_getpc_b64 s[10:11]
L_pc:
    s_add_u32 s10, s10, L_start - L_pc
    s_addc_u32 s11, s11, -1
    v_lshlrev_b32 v18, 7, v0
v_min_u32 v19, L_exit - L_start, v18
global_load_dword v32, v19, s[10:11]
v_add_u32 v18, 8192, v18
v_min_u32 v19, L_exit - L_start, v18
global_load_dword v33, v19, s[10:11]
v_add_u32 v18, 8192, v18
v_min_u32 v19, L_exit - L_start, v18
global_load_dword v34, v19, s[10:11]
v_add_u32 v18, 8192, v18
v_min_u32 v19, L_exit - L_start, v18
global_load_dword v35, v19, s[10:11]
v_add_u32 v18, 8192, v18
L_nocp:
s_lshr_b32 s5, s6, 3
    s_lshl_b32 s5, s5, 13
    s_add_u32 s5, s5, 262144
    s_add_u32 s10, s5, 4096
    s_sleep 64
s_mov_b32 s15, 200000
Lp_13:
s_sleep 8
buffer_load_dwordx4 v[32:35], v3, s[44:47], s5 offen offset:0 sc1
buffer_load_dwordx4 v[36:39], v3, s[44:47], s5 offen offset:1024 sc1
buffer_load_dwordx4 v[40:43], v3, s[44:47], s5 offen offset:2048 sc1
buffer_load_dwordx4 v[44:47], v3, s[44:47], s5 offen offset:3072 sc1
buffer_load_dwordx4 v[48:51], v3, s[44:47], s10 offen offset:0 sc1
buffer_load_dwordx4 v[52:55], v3, s[44:47], s10 offen offset:1024 sc1
buffer_load_dwordx4 v[56:59], v3, s[44:47], s10 offen offset:2048 sc1
buffer_load_dwordx4 v[60:63], v3, s[44:47], s10 offen offset:3072 sc1
s_waitcnt vmcnt(0)
v_max_u32 v24, v33, v35
v_min_u32 v25, v33, v35
v_max3_u32 v24, v24, v37, v39
v_min3_u32 v25, v25, v37, v39
v_max3_u32 v24, v24, v41, v43
v_min3_u32 v25, v25, v41, v43
v_max3_u32 v24, v24, v45, v47
v_min3_u32 v25, v25, v45, v47
v_max3_u32 v24, v24, v49, v51
v_min3_u32 v25, v25, v49, v51
v_max3_u32 v24, v24, v53, v55
v_min3_u32 v25, v25, v53, v55
v_max3_u32 v24, v24, v57, v59
v_min3_u32 v25, v25, v57, v59
v_max3_u32 v24, v24, v61, v63
v_min3_u32 v25, v25, v61, v63
v_cmp_eq_u32 s[12:13], s4, v24
v_cmp_eq_u32 vcc, s4, v25
    s_nop 0
s_and_b64 vcc, vcc, s[12:13]
s_andn2_b64 exec, exec, vcc
    s_cbranch_execz Ld_14
s_sub_u32 s15, s15, 1
    s_cmp_lg_u32 s15, 0
    s_cbranch_scc1 Lp_13
Ld_14:
s_mov_b64 exec, -1
v_add_f32 v32, v32, v36
v_add_f32 v40, v40, v44
v_add_f32 v32, v32, v40
v_add_f32 v34, v34, v38
v_add_f32 v42, v42, v46
v_add_f32 v34, v34, v42
v_cvt_pk_bf16_f32 v32, v32, v34
    ds_write_b16 v17, v32 offset:0
    ds_write_b16_d16_hi v17, v32 offset:16
v_add_f32 v48, v48, v52
v_add_f32 v56, v56, v60
v_add_f32 v48, v48, v56
v_add_f32 v50, v50, v54
v_add_f32 v58, v58, v62
v_add_f32 v50, v50, v58
v_cvt_pk_bf16_f32 v48, v48, v50
    ds_write_b16 v17, v48 offset:256
    ds_write_b16_d16_hi v17, v48 offset:272
s_waitcnt lgkmcnt(0)
    s_barrier
s_endpgm
L_exit:
    s_endpgm

.section .rodata,"a"
.p2align 6
.amdhsa_kernel concat_heads__compressed_kv_cla__sliding_block_cached__decode_kernel
  .amdhsa_next_free_vgpr 256
  .amdhsa_next_free_sgpr 102
  .amdhsa_accum_offset 256
  .amdhsa_group_segment_fixed_size 0
  .amdhsa_kernarg_size 112
  .amdhsa_user_sgpr_count 2
  .amdhsa_user_sgpr_kernarg_segment_ptr 1
  .amdhsa_system_sgpr_workgroup_id_x 1
  .amdhsa_float_denorm_mode_32 3
.end_amdhsa_kernel
```
